```python
import torch

def _softmax(x, axis=-1):
    return torch.softmax(x, dim=axis)
def _gelu(x):
    return torch.nn.functional.gelu(x, approximate="tanh")
def _silu(x):
    return torch.nn.functional.silu(x)
def _sigmoid(x):
    return torch.sigmoid(x)
def _layernorm(x, axis=-1, eps=1e-5):
    m = x.mean(dim=axis, keepdim=True)
    v = x.var(dim=axis, keepdim=True, unbiased=False)
    return (x - m) / torch.sqrt(v + eps)
def _scatter_add(tgt, idx, src, axis=0):
    return tgt.clone().index_add_(axis, idx, src)
def _segment_sum(src, seg, n):
    out = torch.zeros((n,) + src.shape[1:], dtype=src.dtype)
    return out.index_add_(0, seg, src)
def _pad(x, pw):
    flat = tuple(v for pair in reversed(pw) for v in pair)
    return torch.nn.functional.pad(x, flat)

kernel_name = 'parallel_sum__linear_kernel_hedgehog__moe_arch_mod__prompt'

def setup_inputs():

    _w = (lambda a: (lambda t: t.to(torch.bfloat16) if t.is_floating_point() else t)(torch.as_tensor(a)))
    def _A_setup():
        B, S, D, H = 1, 2048, 576, 32
        Dh = D // H
        return {
            "x": _w((lambda *s: torch.randn(*s, dtype=torch.bfloat16) * 0.05)(B, S, D)),
            "wqkv": _w((lambda *s: torch.randn(*s, dtype=torch.bfloat16) * 0.4)(D, 3 * D)),
            "w_phi": _w((lambda *s: torch.randn(*s, dtype=torch.bfloat16) * 0.4)(H, Dh, Dh) * (Dh ** -0.5)),
            "wo": _w((lambda *s: torch.randn(*s, dtype=torch.bfloat16) * 0.1)(D, D)),
        }
    _A_in = _A_setup()

    def _B_setup():
        B, S, D, F, C = 1, 2048, 576, 4608, 1
        return {
            "x": _w((lambda *s: torch.randn(*s, dtype=torch.bfloat16) * 0.05)(B, S, D)),
            "w_r": _w((lambda *s: torch.randn(*s, dtype=torch.bfloat16) * 0.05)(D)),
            "w_gate": _w((lambda *s: torch.randn(*s, dtype=torch.bfloat16) * 0.05)(D, F)),
            "w_up": _w((lambda *s: torch.randn(*s, dtype=torch.bfloat16) * 0.05)(D, F)),
            "w_down": _w((lambda *s: torch.randn(*s, dtype=torch.bfloat16) * 0.05)(F, D)),
        }
    _B_in = _B_setup()

    return {
        "A_x": _A_in["x"],
        "A_wqkv": _A_in["wqkv"],
        "A_w_phi": _A_in["w_phi"],
        "A_wo": _A_in["wo"],
        "B_x": _B_in["x"],
        "B_w_r": _B_in["w_r"],
        "B_w_gate": _B_in["w_gate"],
        "B_w_up": _B_in["w_up"],
        "B_w_down": _B_in["w_down"],
    }

def reference(A_x, A_wqkv, A_w_phi, A_wo, B_x, B_w_r, B_w_gate, B_w_up, B_w_down):
    def _A_ref(x, wqkv, w_phi, wo):
        B, S, D = x.shape
        H = 32; Dh = D // H
        qkv = (lambda x, *d: x.permute(*d))((x @ wqkv).reshape(B, S, 3, H, Dh), 2, 0, 3, 1, 4)
        q, k, v = qkv[0], qkv[1], qkv[2]
        pq = torch.einsum("bhsd,hdf->bhsf", q, w_phi)
        pk = torch.einsum("bhsd,hdf->bhsf", k, w_phi)
        phi_q = torch.concatenate([_softmax(pq, axis=-1), _softmax(-pq, axis=-1)], axis=-1)
        phi_k = torch.concatenate([_softmax(pk, axis=-1), _softmax(-pk, axis=-1)], axis=-1)
        kv = torch.einsum("bhsf,bhsd->bhfd", phi_k, v)
        z  = torch.einsum("bhsf->bhf", phi_k)
        num = torch.einsum("bhqf,bhfd->bhqd", phi_q, kv)
        den = torch.einsum("bhqf,bhf->bhq", phi_q, z)[..., None] + 1e-6
        o = num / den
        return (lambda x, *d: x.permute(*d))(o, 0, 2, 1, 3).reshape(B, S, D) @ wo

    def _B_ref(x, w_r, w_gate, w_up, w_down):
        B, S, D = x.shape
        C = 1
        r = x @ w_r
        idx = torch.argsort(-r, axis=-1)[:, :C]
        idx_e = (lambda x, n, axis: torch.repeat_interleave(x, n, dim=axis))(idx.reshape(B, C, 1), D, axis=2)
        x_sel = (lambda x, i, axis: torch.take_along_dim(x, i, dim=axis))(x, idx_e, axis=1)
        g = _silu(x_sel @ w_gate)
        u = x_sel @ w_up
        y = (g * u) @ w_down
        r_sel = _sigmoid((lambda x, i, axis: torch.take_along_dim(x, i, dim=axis))(r, idx, axis=1))
        y = y * r_sel.reshape(B, C, 1)
        b_off = (torch.arange(B) * S).reshape(B, 1)
        flat_idx = (idx + b_off).reshape(B * C)
        zero = (x * 0.0).reshape(B * S, D)
        upd = _scatter_add(zero, flat_idx, y.reshape(B * C, D), axis=0)
        return x + upd.reshape(B, S, D)

    x = A_x
    xn = _layernorm(x, axis=-1)
    return x + _A_ref(xn, A_wqkv, A_w_phi, A_wo) + _B_ref(xn, B_w_r, B_w_gate, B_w_up, B_w_down)
```

```asm
; @launch grid=(256,1,1) block=(512,1,1) lds=163840
.amdgcn_target "amdgcn-amd-amdhsa--gfx950"
.text
.globl parallel_sum__linear_kernel_hedgehog__moe_arch_mod__prompt_kernel
.p2align 8
.type parallel_sum__linear_kernel_hedgehog__moe_arch_mod__prompt_kernel,@function
parallel_sum__linear_kernel_hedgehog__moe_arch_mod__prompt_kernel:
  s_cmp_ge_u32 s2, 256
  s_cbranch_scc1 L_end
  s_load_dwordx16 s[4:19], s[0:1], 0
  s_load_dwordx8 s[20:27], s[0:1], 64
  s_mov_b32 s60, s2
  v_lshrrev_b32 v2, 6, v0
  v_and_b32 v1, 63, v0
  v_readfirstlane_b32 s48, v2
  s_and_b32 s57, s2, 7
  s_lshr_b32 s58, s2, 3
  s_and_b32 s49, s57, 1
  s_lshl_b32 s49, s49, 3
  s_and_b32 s52, s58, 7
  s_add_u32 s49, s49, s52
  s_lshr_b32 s50, s57, 1
  s_lshl_b32 s50, s50, 2
  s_lshr_b32 s58, s58, 3
  s_lshr_b32 s62, s57, 2
  s_xor_b32 s62, s62, 1
  s_lshr_b32 s63, s58, 1
  s_xor_b32 s62, s62, s63
  s_and_b32 s58, s58, 1
  s_lshl_b32 s58, s58, 1
  s_add_u32 s58, s58, s62
  s_add_u32 s50, s50, s58
  s_lshl_b32 s58, s58, 1
  s_add_u32 s52, s52, s58
  s_cmp_ge_u32 s52, 9
  s_cselect_b32 s57, 9, 0
  s_sub_u32 s52, s52, s57
  s_cmp_ge_u32 s48, 4
  s_cbranch_scc1 L_helper
  s_lshl_b32 s54, s48, 12
  v_and_b32 v84, 3, v1
  v_and_b32 v85, 1, v1
  v_lshrrev_b32 v86, 1, v84
  v_bfe_u32 v87, v1, 4, 1
  v_lshl_add_u32 v86, v87, 1, v86
  v_lshrrev_b32 v89, 5, v1
  v_cmp_eq_u32 vcc, v89, v85
  v_bfe_u32 v87, v1, 2, 2
  v_mul_u32_u24 v90, 24, v89
  v_add_u32 v90, v90, v87
  v_lshlrev_b32 v90, 6, v90
  v_lshl_add_u32 v90, v86, 3, v90
  v_add_u32 v90, 131072, v90
  v_mov_b32 v88, 134144
  v_cndmask_b32 v19, v88, v90, vcc
  s_and_b32 s57, s50, 1
  v_lshlrev_b32 v88, 2, v85
  v_add_u32 v88, s57, v88
  v_lshlrev_b32 v89, 11, v89
  v_lshl_add_u32 v89, v87, 8, v89
  v_lshlrev_b32 v87, 2, v87
  v_add_u32 v90, v88, v86
  v_lshrrev_b32 v84, 1, v90
  v_add_u32 v84, 0, v84
  v_add_u32 v84, v84, v87
  v_and_b32 v84, 15, v84
  v_lshl_add_u32 v84, v84, 4, v89
  v_and_b32 v90, 1, v90
  v_lshl_add_u32 v2, v90, 3, v84
  v_add_u32 v6, 0x10000, v2
  v_add_u32 v90, v88, v86
  v_lshrrev_b32 v84, 1, v90
  v_add_u32 v84, 5, v84
  v_add_u32 v84, v84, v87
  v_and_b32 v84, 15, v84
  v_lshl_add_u32 v84, v84, 4, v89
  v_and_b32 v90, 1, v90
  v_lshl_add_u32 v3, v90, 3, v84
  v_add_u32 v7, 0x10000, v3
  v_add_u32 v90, v88, v86
  v_lshrrev_b32 v84, 1, v90
  v_add_u32 v84, 10, v84
  v_add_u32 v84, v84, v87
  v_and_b32 v84, 15, v84
  v_lshl_add_u32 v84, v84, 4, v89
  v_and_b32 v90, 1, v90
  v_lshl_add_u32 v4, v90, 3, v84
  v_add_u32 v8, 0x10000, v4
  v_add_u32 v90, 4, v88
  v_lshrrev_b32 v84, 1, v90
  v_min_u32 v85, 2, v86
  v_mul_u32_u24 v85, 5, v85
  v_add_u32 v84, v84, v85
  v_add_u32 v84, v84, v87
  v_and_b32 v84, 15, v84
  v_lshl_add_u32 v84, v84, 4, v89
  v_and_b32 v90, 1, v90
  v_lshl_add_u32 v5, v90, 3, v84
  v_add_u32 v9, 0x10000, v5
  v_and_b32 v84, 31, v1
  v_lshrrev_b32 v85, 1, v84
  v_and_b32 v85, 7, v85
  v_lshrrev_b32 v86, 5, v1
  v_xor_b32 v85, v85, v86
  v_lshlrev_b32 v85, 4, v85
  v_lshl_add_u32 v85, v84, 7, v85
  v_add_u32 v85, s54, v85
  v_xor_b32 v10, 0, v85
  v_add_u32 v14, 0x10000, v10
  v_xor_b32 v11, 32, v85
  v_add_u32 v15, 0x10000, v11
  v_xor_b32 v12, 64, v85
  v_add_u32 v16, 0x10000, v12
  v_xor_b32 v13, 96, v85
  v_add_u32 v17, 0x10000, v13
  v_lshrrev_b32 v85, 4, v1
  v_xor_b32 v85, v85, v1
  v_and_b32 v85, 1, v85
  v_cmp_eq_u32 vcc, 0, v85
  v_mov_b32 v85, 0x3f803f80
  s_nop 0
  v_cndmask_b32 v20, 0, v85, vcc
  v_cndmask_b32 v21, 0, v85, vcc
  v_cndmask_b32 v22, 0, v85, vcc
  v_cndmask_b32 v23, 0, v85, vcc
  s_lshl_b32 s57, s49, 7
  s_lshl_b32 s58, s48, 5
  s_add_u32 s57, s57, s58
  v_add_u32 v84, s57, v84
  v_lshlrev_b32 v84, 4, v84
  v_add_u32 v18, 4096, v84
  v_mov_b32 v68, 0
  v_mov_b32 v69, 0
  v_mov_b32 v70, 0
  v_mov_b32 v71, 0
  v_mov_b32 v72, 0
  v_mov_b32 v73, 0
  v_mov_b32 v74, 0
  v_mov_b32 v75, 0
  v_mov_b32 v76, 0
  v_mov_b32 v77, 0
  v_mov_b32 v78, 0
  v_mov_b32 v79, 0
  v_mov_b32 v80, 0
  v_mov_b32 v81, 0
  v_mov_b32 v82, 0
  v_mov_b32 v83, 0
  v_and_b32 v84, 31, v1
  v_lshrrev_b32 v85, 5, v1
  v_lshl_add_u32 v84, v85, 7, v84
  s_lshl_b32 s57, s48, 5
  v_add_u32 v84, s57, v84
  v_mul_u32_u24 v84, 160, v84
  v_add_u32 v91, 83968, v84
  s_and_b32 s57, s48, 1
  s_lshr_b32 s58, s48, 1
  v_lshrrev_b32 v84, 4, v1
  v_bfe_u32 v85, v1, 2, 2
  v_lshl_add_u32 v84, v84, 2, v85
  s_lshl_b32 s62, s57, 7
  v_add_u32 v84, s62, v84
  v_mul_u32_u24 v84, 160, v84
  v_and_b32 v85, 3, v1
  v_lshl_add_u32 v84, v85, 3, v84
  v_add_u32 v84, 83968, v84
  s_lshl_b32 s62, s58, 5
  v_add_u32 v93, s62, v84
  v_add_u32 v92, 48, v84
  v_and_b32 v86, 15, v1
  v_lshrrev_b32 v87, 4, v1
  v_mov_b32 v90, 0x7fff0000
  s_cmp_eq_u32 s58, 0
  s_cbranch_scc0 Ld1_1
  v_lshlrev_b32 v94, 4, v1
  v_lshlrev_b32 v95, 3, v86
  v_add_u32 v95, 1024, v95
  v_cmp_eq_u32 vcc, 0, v87
  s_nop 1
  v_cndmask_b32 v95, v90, v95, vcc
  s_branch Ldj_2
Ld1_1:
  v_lshl_add_u32 v94, v87, 2, v86
  v_lshlrev_b32 v94, 4, v94
  v_add_u32 v94, 1152, v94
  v_lshlrev_b32 v95, 3, v86
  v_add_u32 v95, 1408, v95
  v_cmp_gt_u32 vcc, 4, v86
  s_nop 1
  v_cndmask_b32 v94, v90, v94, vcc
  v_cmp_gt_u32 vcc, 4, v1
  s_nop 1
  v_cndmask_b32 v95, v90, v95, vcc
Ldj_2:
  s_mul_i32 s62, s50, 16
  s_add_u32 s62, s62, s49
  s_mul_i32 s62, s62, 3072
  s_mul_i32 s63, s57, 1536
  s_add_u32 s62, s62, s63
  s_add_u32 s3, s62, 65536
  s_waitcnt lgkmcnt(0)
  s_mov_b32 s28, s4
  s_mov_b32 s29, s5
  s_mov_b32 s30, 2359296
  s_mov_b32 s31, 0x00020000
  s_mov_b32 s36, s26
  s_mov_b32 s37, s27
  s_mov_b32 s38, 33554432
  s_mov_b32 s39, 0x00020000
  s_load_dword s61, s[26:27], 0
  s_and_b32 s62, s60, 7
  s_lshr_b32 s63, s60, 3
  s_and_b32 s44, s62, 3
  s_lshl_b32 s44, s44, 3
  s_and_b32 s46, s63, 7
  s_add_u32 s44, s44, s46
  s_lshr_b32 s45, s62, 2
  s_lshl_b32 s45, s45, 2
  s_lshr_b32 s46, s63, 3
  s_add_u32 s45, s45, s46
  s_mov_b32 s40, s14
  s_mov_b32 s41, s15
  s_mov_b32 s42, 1152
  s_mov_b32 s43, 0x00020000
  v_and_b32 v116, 31, v1
  v_lshlrev_b32 v116, 2, v116
  v_lshrrev_b32 v117, 5, v1
  s_lshl_b32 s57, s60, 3
  s_lshl_b32 s58, s48, 1
  s_add_u32 s57, s57, s58
  v_add_u32 v117, s57, v117
  v_mul_u32_u24 v118, 1152, v117
  v_add_u32 v118, v118, v116
  buffer_load_dword v126, v118, s[28:31], 0 offen offset:0
  buffer_load_dword v127, v118, s[28:31], 0 offen offset:128
  buffer_load_dword v128, v118, s[28:31], 0 offen offset:256
  buffer_load_dword v129, v118, s[28:31], 0 offen offset:384
  buffer_load_dword v130, v118, s[28:31], 0 offen offset:512
  buffer_load_dword v131, v118, s[28:31], 0 offen offset:640
  buffer_load_dword v132, v118, s[28:31], 0 offen offset:768
  buffer_load_dword v133, v118, s[28:31], 0 offen offset:896
  buffer_load_dword v134, v118, s[28:31], 0 offen offset:1024
  buffer_load_dword v136, v116, s[40:43], 0 offen offset:0
  buffer_load_dword v137, v116, s[40:43], 0 offen offset:128
  buffer_load_dword v138, v116, s[40:43], 0 offen offset:256
  buffer_load_dword v139, v116, s[40:43], 0 offen offset:384
  buffer_load_dword v140, v116, s[40:43], 0 offen offset:512
  buffer_load_dword v141, v116, s[40:43], 0 offen offset:640
  buffer_load_dword v142, v116, s[40:43], 0 offen offset:768
  buffer_load_dword v143, v116, s[40:43], 0 offen offset:896
  buffer_load_dword v144, v116, s[40:43], 0 offen offset:1024
  v_lshlrev_b32 v146, 4, v117
  v_add_u32 v146, 4096, v146
  s_mov_b32 s40, s8
  s_mov_b32 s41, s9
  s_mov_b32 s42, 20736
  s_mov_b32 s43, 0x00020000
  v_and_b32 v115, 15, v1
  v_lshrrev_b32 v116, 4, v1
  s_lshl_b32 s57, s48, 2
  v_add_u32 v116, s57, v116
  s_mul_i32 s57, s50, 36
  v_mov_b32 v121, 0x7fff0000
  v_add_u32 v117, 0, v116
  v_cmp_le_u32 vcc, 24, v117
  s_nop 1
  v_cndmask_b32 v118, 0, 1, vcc
  v_mul_u32_u24 v119, 26, v118
  v_sub_u32 v119, v117, v119
  v_mul_u32_u24 v120, 18, v118
  v_add3_u32 v120, v120, v119, s57
  v_mul_u32_u24 v120, 36, v120
  v_lshl_add_u32 v120, v115, 2, v120
  v_cmp_gt_u32 vcc, 18, v119
  v_cmp_gt_u32 s[62:63], 9, v115
  s_nop 0
  s_and_b64 vcc, vcc, s[62:63]
  v_cndmask_b32 v120, v121, v120, vcc
  buffer_load_dword v147, v120, s[40:43], 0 offen
  v_add_u32 v117, 16, v116
  v_cmp_le_u32 vcc, 24, v117
  s_nop 1
  v_cndmask_b32 v118, 0, 1, vcc
  v_mul_u32_u24 v119, 26, v118
  v_sub_u32 v119, v117, v119
  v_mul_u32_u24 v120, 18, v118
  v_add3_u32 v120, v120, v119, s57
  v_mul_u32_u24 v120, 36, v120
  v_lshl_add_u32 v120, v115, 2, v120
  v_cmp_gt_u32 vcc, 18, v119
  v_cmp_gt_u32 s[62:63], 9, v115
  s_nop 0
  s_and_b64 vcc, vcc, s[62:63]
  v_cndmask_b32 v120, v121, v120, vcc
  buffer_load_dword v148, v120, s[40:43], 0 offen
  v_add_u32 v117, 32, v116
  v_cmp_le_u32 vcc, 24, v117
  s_nop 1
  v_cndmask_b32 v118, 0, 1, vcc
  v_mul_u32_u24 v119, 26, v118
  v_sub_u32 v119, v117, v119
  v_mul_u32_u24 v120, 18, v118
  v_add3_u32 v120, v120, v119, s57
  v_mul_u32_u24 v120, 36, v120
  v_lshl_add_u32 v120, v115, 2, v120
  v_cmp_gt_u32 vcc, 18, v119
  v_cmp_gt_u32 s[62:63], 9, v115
  s_nop 0
  s_and_b64 vcc, vcc, s[62:63]
  v_cndmask_b32 v120, v121, v120, vcc
  buffer_load_dword v149, v120, s[40:43], 0 offen
  s_mov_b32 s40, s10
  s_mov_b32 s41, s11
  s_mov_b32 s42, 663552
  s_mov_b32 s43, 0x00020000
  s_and_b32 s12, s60, 7
  s_lshr_b32 s13, s60, 3
  v_lshrrev_b32 v115, 1, v1
  v_mul_u32_u24 v115, 1152, v115
  v_and_b32 v116, 1, v1
  v_lshl_add_u32 v115, v116, 4, v115
  s_mul_i32 s62, s13, 36864
  s_mul_i32 s63, s12, 144
  s_add_u32 s62, s62, s63
  s_lshl_b32 s63, s48, 5
  s_add_u32 s63, s63, s62
  s_lshl_b32 s57, s48, 10
  s_add_u32 m0, s57, 152064
  s_cmp_lt_u32 s60, 144
  s_cselect_b32 s63, s63, 0x7fff0000
  buffer_load_dwordx4 v115, s[40:43], s63 offen lds
  s_add_u32 s63, s62, 128
  s_cmp_eq_u32 s48, 0
  s_cselect_b32 s57, 0, 1024
  s_add_u32 m0, s57, 156160
  s_cmp_lt_u32 s60, 144
  s_cselect_b32 s63, s63, 0x7fff0000
  buffer_load_dwordx4 v115, s[40:43], s63 offen lds
  s_waitcnt vmcnt(5)
  v_lshlrev_b32 v158, 16, v126
  v_and_b32 v159, 0xffff0000, v126
  v_lshlrev_b32 v160, 16, v127
  v_and_b32 v161, 0xffff0000, v127
  v_lshlrev_b32 v162, 16, v128
  v_and_b32 v163, 0xffff0000, v128
  v_lshlrev_b32 v164, 16, v129
  v_and_b32 v165, 0xffff0000, v129
  v_lshlrev_b32 v166, 16, v130
  v_and_b32 v167, 0xffff0000, v130
  v_lshlrev_b32 v168, 16, v131
  v_and_b32 v169, 0xffff0000, v131
  v_lshlrev_b32 v170, 16, v132
  v_and_b32 v171, 0xffff0000, v132
  v_lshlrev_b32 v172, 16, v133
  v_and_b32 v173, 0xffff0000, v133
  v_lshlrev_b32 v174, 16, v134
  v_and_b32 v175, 0xffff0000, v134
  v_pk_add_f32 v[194:195], v[158:159], v[160:161]
  v_pk_add_f32 v[194:195], v[194:195], v[162:163]
  v_pk_add_f32 v[194:195], v[194:195], v[164:165]
  v_pk_add_f32 v[194:195], v[194:195], v[166:167]
  v_pk_add_f32 v[194:195], v[194:195], v[168:169]
  v_pk_add_f32 v[194:195], v[194:195], v[170:171]
  v_pk_add_f32 v[194:195], v[194:195], v[172:173]
  v_pk_add_f32 v[194:195], v[194:195], v[174:175]
  v_add_f32 v194, v194, v195
  v_lshlrev_b32 v176, 16, v136
  v_and_b32 v177, 0xffff0000, v136
  v_lshlrev_b32 v178, 16, v137
  v_and_b32 v179, 0xffff0000, v137
  v_lshlrev_b32 v180, 16, v138
  v_and_b32 v181, 0xffff0000, v138
  v_lshlrev_b32 v182, 16, v139
  v_and_b32 v183, 0xffff0000, v139
  v_lshlrev_b32 v184, 16, v140
  v_and_b32 v185, 0xffff0000, v140
  v_lshlrev_b32 v186, 16, v141
  v_and_b32 v187, 0xffff0000, v141
  v_lshlrev_b32 v188, 16, v142
  v_and_b32 v189, 0xffff0000, v142
  v_lshlrev_b32 v190, 16, v143
  v_and_b32 v191, 0xffff0000, v143
  v_lshlrev_b32 v192, 16, v144
  v_and_b32 v193, 0xffff0000, v144
  v_add_f32_dpp v194, v194, v194 quad_perm:[1,0,3,2] row_mask:0xf bank_mask:0xf
  s_nop 1
  v_add_f32_dpp v194, v194, v194 quad_perm:[2,3,0,1] row_mask:0xf bank_mask:0xf
  s_nop 1
  v_add_f32_dpp v194, v194, v194 row_half_mirror row_mask:0xf bank_mask:0xf
  s_nop 1
  v_add_f32_dpp v194, v194, v194 row_mirror row_mask:0xf bank_mask:0xf
  v_mov_b32 v198, v194
  s_nop 1
  v_permlane16_swap_b32 v194, v198
  v_add_f32 v194, v194, v198
  v_mul_f32 v202, 0x3ae38e39, v194
  v_sub_f32 v196, 0, v202
  v_pk_add_f32 v[158:159], v[158:159], v[196:197] op_sel_hi:[1,0]
  v_pk_add_f32 v[160:161], v[160:161], v[196:197] op_sel_hi:[1,0]
  v_pk_add_f32 v[162:163], v[162:163], v[196:197] op_sel_hi:[1,0]
  v_pk_add_f32 v[164:165], v[164:165], v[196:197] op_sel_hi:[1,0]
  v_pk_add_f32 v[166:167], v[166:167], v[196:197] op_sel_hi:[1,0]
  v_pk_add_f32 v[168:169], v[168:169], v[196:197] op_sel_hi:[1,0]
  v_pk_add_f32 v[170:171], v[170:171], v[196:197] op_sel_hi:[1,0]
  v_pk_add_f32 v[172:173], v[172:173], v[196:197] op_sel_hi:[1,0]
  v_pk_add_f32 v[174:175], v[174:175], v[196:197] op_sel_hi:[1,0]
  v_pk_mul_f32 v[194:195], v[158:159], v[158:159]
  v_pk_mul_f32 v[198:199], v[158:159], v[176:177]
  v_pk_fma_f32 v[194:195], v[160:161], v[160:161], v[194:195]
  v_pk_fma_f32 v[198:199], v[160:161], v[178:179], v[198:199]
  v_pk_fma_f32 v[194:195], v[162:163], v[162:163], v[194:195]
  v_pk_fma_f32 v[198:199], v[162:163], v[180:181], v[198:199]
  v_pk_fma_f32 v[194:195], v[164:165], v[164:165], v[194:195]
  v_pk_fma_f32 v[198:199], v[164:165], v[182:183], v[198:199]
  v_pk_fma_f32 v[194:195], v[166:167], v[166:167], v[194:195]
  v_pk_fma_f32 v[198:199], v[166:167], v[184:185], v[198:199]
  v_pk_fma_f32 v[194:195], v[168:169], v[168:169], v[194:195]
  v_pk_fma_f32 v[198:199], v[168:169], v[186:187], v[198:199]
  v_pk_fma_f32 v[194:195], v[170:171], v[170:171], v[194:195]
  v_pk_fma_f32 v[198:199], v[170:171], v[188:189], v[198:199]
  v_pk_fma_f32 v[194:195], v[172:173], v[172:173], v[194:195]
  v_pk_fma_f32 v[198:199], v[172:173], v[190:191], v[198:199]
  v_pk_fma_f32 v[194:195], v[174:175], v[174:175], v[194:195]
  v_pk_fma_f32 v[198:199], v[174:175], v[192:193], v[198:199]
  v_add_f32 v194, v194, v195
  v_add_f32 v196, v198, v199
  s_nop 0
  v_add_f32_dpp v194, v194, v194 quad_perm:[1,0,3,2] row_mask:0xf bank_mask:0xf
  v_add_f32_dpp v196, v196, v196 quad_perm:[1,0,3,2] row_mask:0xf bank_mask:0xf
  s_nop 0
  v_add_f32_dpp v194, v194, v194 quad_perm:[2,3,0,1] row_mask:0xf bank_mask:0xf
  v_add_f32_dpp v196, v196, v196 quad_perm:[2,3,0,1] row_mask:0xf bank_mask:0xf
  s_nop 0
  v_add_f32_dpp v194, v194, v194 row_half_mirror row_mask:0xf bank_mask:0xf
  v_add_f32_dpp v196, v196, v196 row_half_mirror row_mask:0xf bank_mask:0xf
  s_nop 0
  v_add_f32_dpp v194, v194, v194 row_mirror row_mask:0xf bank_mask:0xf
  v_add_f32_dpp v196, v196, v196 row_mirror row_mask:0xf bank_mask:0xf
  v_mov_b32 v198, v194
  v_mov_b32 v199, v196
  s_nop 0
  v_permlane16_swap_b32 v194, v198
  v_permlane16_swap_b32 v196, v199
  v_add_f32 v194, v194, v198
  v_add_f32 v196, v196, v199
  v_mov_b32 v203, 0x3727c5ac
  v_fmac_f32 v203, 0x3ae38e39, v194
  v_rsq_f32 v203, v203
  s_waitcnt lgkmcnt(0)
  s_mul_i32 s61, s61, 0x9e3779b1
  s_add_u32 s51, s61, 0x7f4a7c15
  v_mul_f32 v204, v196, v203
  v_mov_b32 v205, s51
  v_mov_b32 v206, v204
  v_mov_b32 v207, v204
  s_nop 1
  v_permlane32_swap_b32 v206, v207
  v_cmp_gt_f32 vcc, v207, v206
  v_max_f32 v208, v206, v207
  v_and_b32 v209, 0xfffffffe, v205
  v_cndmask_b32 v210, 0, 1, vcc
  v_or_b32 v209, v209, v210
  s_lshl_b32 s57, s60, 2
  s_add_u32 s57, s57, s48
  s_lshl_b32 s57, s57, 3
  s_add_u32 s57, s57, 36864
  v_mov_b32 v210, s57
  s_mov_b32 exec_lo, 1
  s_mov_b32 exec_hi, 1
  buffer_store_dwordx4 v[202:205], v146, s[36:39], 0 offen sc1
  s_mov_b64 exec, 1
  buffer_store_dwordx2 v[208:209], v210, s[36:39], 0 offen sc1
  s_mov_b64 exec, -1
  s_waitcnt vmcnt(4)
  v_lshlrev_b32 v115, 2, v1
  s_lshl_b32 s57, s48, 8
  v_add_u32 v115, s57, v115
  v_add_u32 v116, 131072, v115
  ds_write_b32 v116, v147 offset:0
  ds_write_b32 v116, v148 offset:1024
  ds_write_b32 v116, v149 offset:2048
  v_mov_b32 v122, 0
  v_mov_b32 v123, 0
  v_mov_b32 v124, 0
  v_mov_b32 v125, 0
  v_lshlrev_b32 v115, 2, v115
  v_add_u32 v116, 137728, v115
  ds_write_b128 v116, v[122:125]
  v_add_u32 v116, 134144, v115
  v_cmp_gt_u32 vcc, 1536, v115
  s_nop 0
  s_and_saveexec_b64 s[62:63], vcc
  ds_write_b128 v116, v[122:125]
  s_mov_b64 exec, s[62:63]
  v_lshlrev_b32 v116, 4, v1
  v_add_u32 v116, 158208, v116
  s_mov_b32 exec_hi, 0xff
  ds_write_b128 v116, v[122:125]
  ds_write_b128 v116, v[122:125] offset:640
  s_mov_b64 exec, -1
  s_waitcnt vmcnt(2)
  v_lshrrev_b32 v115, 4, v1
  v_bfe_u32 v116, v1, 2, 2
  v_lshl_add_u32 v115, v115, 3, v116
  v_lshlrev_b32 v115, 5, v115
  v_and_b32 v116, 3, v1
  v_lshl_add_u32 v115, v116, 3, v115
  s_lshl_b32 s57, s48, 10
  s_add_u32 s57, s57, 152064
  v_add_u32 v116, s57, v115
  v_add_u32 v117, 156160, v115
  ds_read_b64_tr_b16 v[126:127], v116
  ds_read_b64_tr_b16 v[128:129], v116 offset:128
  ds_read_b64_tr_b16 v[130:131], v117
  ds_read_b64_tr_b16 v[132:133], v117 offset:128
  s_mul_i32 s62, s12, 18
  s_add_u32 s62, s62, s13
  s_mul_i32 s62, s62, 4608
  s_add_u32 s62, s62, 4194304
  s_lshl_b32 s63, s48, 10
  s_add_u32 s63, s63, s62
  s_cmp_lt_u32 s60, 144
  s_cselect_b32 s63, s63, 0x7fff0000
  s_cselect_b32 s62, s62, 0x7fff0000
  v_lshlrev_b32 v115, 4, v1
  v_lshrrev_b32 v116, 4, v1
  v_and_b32 v117, 15, v1
  v_lshl_add_u32 v116, v116, 3, v117
  v_lshlrev_b32 v116, 4, v116
  v_add_u32 v116, 4096, v116
  v_cmp_gt_u32 vcc, 8, v117
  v_mov_b32 v117, 0x7fff0000
  s_nop 0
  v_cndmask_b32 v116, v117, v116, vcc
  s_cmp_eq_u32 s48, 0
  s_cselect_b32 s62, s62, 0x7fff0000
  s_waitcnt lgkmcnt(0)
  buffer_store_dwordx4 v[126:129], v115, s[36:39], s63 offen sc1
  buffer_store_dwordx4 v[130:133], v116, s[36:39], s62 offen sc1
  s_setprio 1
  s_barrier
  ds_read_b128 v[28:31], v10 offset:0
  ds_read_b64_tr_b16 v[32:33], v2 offset:16384
  ds_read_b64_tr_b16 v[34:35], v2 offset:17408
  ds_read_b64_tr_b16 v[36:37], v3 offset:16384
  ds_read_b64_tr_b16 v[38:39], v3 offset:17408
  ds_read_b64_tr_b16 v[40:41], v4 offset:16384
  ds_read_b64_tr_b16 v[42:43], v4 offset:17408
  ds_read_b64_tr_b16 v[44:45], v5 offset:16384
  ds_read_b64_tr_b16 v[46:47], v5 offset:17408
  s_waitcnt lgkmcnt(6)
  v_mfma_f32_32x32x16_bf16 v[96:111], v[32:35], v[28:31], 0
  ds_read_b128 v[48:51], v11 offset:0
  ds_read_b64_tr_b16 v[52:53], v2 offset:20480
  ds_read_b64_tr_b16 v[54:55], v2 offset:21504
  ds_read_b64_tr_b16 v[56:57], v3 offset:20480
  ds_read_b64_tr_b16 v[58:59], v3 offset:21504
  s_waitcnt lgkmcnt(9)
  v_mfma_f32_32x32x16_bf16 v[112:127], v[36:39], v[28:31], 0
  ds_read_b64_tr_b16 v[60:61], v4 offset:20480
  ds_read_b64_tr_b16 v[62:63], v4 offset:21504
  ds_read_b64_tr_b16 v[64:65], v5 offset:20480
  ds_read_b64_tr_b16 v[66:67], v5 offset:21504
  s_waitcnt lgkmcnt(11)
  v_mfma_f32_32x32x16_bf16 v[128:143], v[40:43], v[28:31], 0
  s_waitcnt lgkmcnt(9)
  v_mfma_f32_32x32x16_bf16 v[144:159], v[44:47], v[28:31], 0
  s_cmp_eq_u32 s48, 0
  s_cbranch_scc0 Ls_3
  v_mfma_f32_16x16x32_bf16 v[68:71], v[20:23], v[32:35], v[68:71]
  v_mfma_f32_16x16x32_bf16 v[72:75], v[20:23], v[36:39], v[72:75]
  v_mfma_f32_16x16x32_bf16 v[76:79], v[20:23], v[40:43], v[76:79]
  v_mfma_f32_16x16x32_bf16 v[80:83], v[20:23], v[44:47], v[80:83]
Ls_3:
  s_waitcnt lgkmcnt(6)
  v_mfma_f32_32x32x16_bf16 v[96:111], v[52:55], v[48:51], v[96:111]
  ds_read_b128 v[28:31], v12 offset:0
  ds_read_b64_tr_b16 v[32:33], v2 offset:24576
  ds_read_b64_tr_b16 v[34:35], v2 offset:25600
  ds_read_b64_tr_b16 v[36:37], v3 offset:24576
  ds_read_b64_tr_b16 v[38:39], v3 offset:25600
  s_waitcnt lgkmcnt(9)
  v_mfma_f32_32x32x16_bf16 v[112:127], v[56:59], v[48:51], v[112:127]
  ds_read_b64_tr_b16 v[40:41], v4 offset:24576
  ds_read_b64_tr_b16 v[42:43], v4 offset:25600
  ds_read_b64_tr_b16 v[44:45], v5 offset:24576
  ds_read_b64_tr_b16 v[46:47], v5 offset:25600
  s_waitcnt lgkmcnt(11)
  v_mfma_f32_32x32x16_bf16 v[128:143], v[60:63], v[48:51], v[128:143]
  s_waitcnt lgkmcnt(9)
  v_mfma_f32_32x32x16_bf16 v[144:159], v[64:67], v[48:51], v[144:159]
  s_cmp_eq_u32 s48, 1
  s_cbranch_scc0 Ls_4
  v_mfma_f32_16x16x32_bf16 v[68:71], v[20:23], v[52:55], v[68:71]
  v_mfma_f32_16x16x32_bf16 v[72:75], v[20:23], v[56:59], v[72:75]
  v_mfma_f32_16x16x32_bf16 v[76:79], v[20:23], v[60:63], v[76:79]
  v_mfma_f32_16x16x32_bf16 v[80:83], v[20:23], v[64:67], v[80:83]
Ls_4:
  s_waitcnt lgkmcnt(6)
  v_mfma_f32_32x32x16_bf16 v[96:111], v[32:35], v[28:31], v[96:111]
  ds_read_b128 v[48:51], v13 offset:0
  ds_read_b64_tr_b16 v[52:53], v2 offset:28672
  ds_read_b64_tr_b16 v[54:55], v2 offset:29696
  ds_read_b64_tr_b16 v[56:57], v3 offset:28672
  ds_read_b64_tr_b16 v[58:59], v3 offset:29696
  s_waitcnt lgkmcnt(9)
  v_mfma_f32_32x32x16_bf16 v[112:127], v[36:39], v[28:31], v[112:127]
  ds_read_b64_tr_b16 v[60:61], v4 offset:28672
  ds_read_b64_tr_b16 v[62:63], v4 offset:29696
  ds_read_b64_tr_b16 v[64:65], v5 offset:28672
  ds_read_b64_tr_b16 v[66:67], v5 offset:29696
  s_waitcnt lgkmcnt(11)
  v_mfma_f32_32x32x16_bf16 v[128:143], v[40:43], v[28:31], v[128:143]
  s_waitcnt lgkmcnt(9)
  v_mfma_f32_32x32x16_bf16 v[144:159], v[44:47], v[28:31], v[144:159]
  s_cmp_eq_u32 s48, 2
  s_cbranch_scc0 Ls_5
  v_mfma_f32_16x16x32_bf16 v[68:71], v[20:23], v[32:35], v[68:71]
  v_mfma_f32_16x16x32_bf16 v[72:75], v[20:23], v[36:39], v[72:75]
  v_mfma_f32_16x16x32_bf16 v[76:79], v[20:23], v[40:43], v[76:79]
  v_mfma_f32_16x16x32_bf16 v[80:83], v[20:23], v[44:47], v[80:83]
Ls_5:
  s_waitcnt lgkmcnt(0)
  s_barrier
  v_mfma_f32_32x32x16_bf16 v[96:111], v[52:55], v[48:51], v[96:111]
  ds_read_b128 v[28:31], v10 offset:32768
  ds_read_b64_tr_b16 v[32:33], v2 offset:49152
  ds_read_b64_tr_b16 v[34:35], v2 offset:50176
  ds_read_b64_tr_b16 v[36:37], v3 offset:49152
  ds_read_b64_tr_b16 v[38:39], v3 offset:50176
  v_mfma_f32_32x32x16_bf16 v[112:127], v[56:59], v[48:51], v[112:127]
  ds_read_b64_tr_b16 v[40:41], v4 offset:49152
  ds_read_b64_tr_b16 v[42:43], v4 offset:50176
  ds_read_b64_tr_b16 v[44:45], v5 offset:49152
  ds_read_b64_tr_b16 v[46:47], v5 offset:50176
  v_mfma_f32_32x32x16_bf16 v[128:143], v[60:63], v[48:51], v[128:143]
  v_mfma_f32_32x32x16_bf16 v[144:159], v[64:67], v[48:51], v[144:159]
  s_cmp_eq_u32 s48, 3
  s_cbranch_scc0 Ls_6
  v_mfma_f32_16x16x32_bf16 v[68:71], v[20:23], v[52:55], v[68:71]
  v_mfma_f32_16x16x32_bf16 v[72:75], v[20:23], v[56:59], v[72:75]
  v_mfma_f32_16x16x32_bf16 v[76:79], v[20:23], v[60:63], v[76:79]
  v_mfma_f32_16x16x32_bf16 v[80:83], v[20:23], v[64:67], v[80:83]
Ls_6:
  s_waitcnt lgkmcnt(6)
  v_mfma_f32_32x32x16_bf16 v[96:111], v[32:35], v[28:31], v[96:111]
  ds_read_b128 v[48:51], v11 offset:32768
  ds_read_b64_tr_b16 v[52:53], v2 offset:53248
  ds_read_b64_tr_b16 v[54:55], v2 offset:54272
  ds_read_b64_tr_b16 v[56:57], v3 offset:53248
  ds_read_b64_tr_b16 v[58:59], v3 offset:54272
  s_waitcnt lgkmcnt(9)
  v_mfma_f32_32x32x16_bf16 v[112:127], v[36:39], v[28:31], v[112:127]
  ds_read_b64_tr_b16 v[60:61], v4 offset:53248
  ds_read_b64_tr_b16 v[62:63], v4 offset:54272
  ds_read_b64_tr_b16 v[64:65], v5 offset:53248
  ds_read_b64_tr_b16 v[66:67], v5 offset:54272
  s_waitcnt lgkmcnt(11)
  v_mfma_f32_32x32x16_bf16 v[128:143], v[40:43], v[28:31], v[128:143]
  s_waitcnt lgkmcnt(9)
  v_mfma_f32_32x32x16_bf16 v[144:159], v[44:47], v[28:31], v[144:159]
  s_cmp_eq_u32 s48, 0
  s_cbranch_scc0 Ls_7
  v_mfma_f32_16x16x32_bf16 v[68:71], v[20:23], v[32:35], v[68:71]
  v_mfma_f32_16x16x32_bf16 v[72:75], v[20:23], v[36:39], v[72:75]
  v_mfma_f32_16x16x32_bf16 v[76:79], v[20:23], v[40:43], v[76:79]
  v_mfma_f32_16x16x32_bf16 v[80:83], v[20:23], v[44:47], v[80:83]
Ls_7:
  s_waitcnt lgkmcnt(6)
  v_mfma_f32_32x32x16_bf16 v[96:111], v[52:55], v[48:51], v[96:111]
  ds_read_b128 v[28:31], v12 offset:32768
  ds_read_b64_tr_b16 v[32:33], v2 offset:57344
  ds_read_b64_tr_b16 v[34:35], v2 offset:58368
  ds_read_b64_tr_b16 v[36:37], v3 offset:57344
  ds_read_b64_tr_b16 v[38:39], v3 offset:58368
  s_waitcnt lgkmcnt(9)
  v_mfma_f32_32x32x16_bf16 v[112:127], v[56:59], v[48:51], v[112:127]
  ds_read_b64_tr_b16 v[40:41], v4 offset:57344
  ds_read_b64_tr_b16 v[42:43], v4 offset:58368
  ds_read_b64_tr_b16 v[44:45], v5 offset:57344
  ds_read_b64_tr_b16 v[46:47], v5 offset:58368
  s_waitcnt lgkmcnt(11)
  v_mfma_f32_32x32x16_bf16 v[128:143], v[60:63], v[48:51], v[128:143]
  s_waitcnt lgkmcnt(9)
  v_mfma_f32_32x32x16_bf16 v[144:159], v[64:67], v[48:51], v[144:159]
  s_cmp_eq_u32 s48, 1
  s_cbranch_scc0 Ls_8
  v_mfma_f32_16x16x32_bf16 v[68:71], v[20:23], v[52:55], v[68:71]
  v_mfma_f32_16x16x32_bf16 v[72:75], v[20:23], v[56:59], v[72:75]
  v_mfma_f32_16x16x32_bf16 v[76:79], v[20:23], v[60:63], v[76:79]
  v_mfma_f32_16x16x32_bf16 v[80:83], v[20:23], v[64:67], v[80:83]
Ls_8:
  s_waitcnt lgkmcnt(6)
  v_mfma_f32_32x32x16_bf16 v[96:111], v[32:35], v[28:31], v[96:111]
  ds_read_b128 v[48:51], v13 offset:32768
  ds_read_b64_tr_b16 v[52:53], v2 offset:61440
  ds_read_b64_tr_b16 v[54:55], v2 offset:62464
  ds_read_b64_tr_b16 v[56:57], v3 offset:61440
  ds_read_b64_tr_b16 v[58:59], v3 offset:62464
  s_waitcnt lgkmcnt(9)
  v_mfma_f32_32x32x16_bf16 v[112:127], v[36:39], v[28:31], v[112:127]
  ds_read_b64_tr_b16 v[60:61], v4 offset:61440
  ds_read_b64_tr_b16 v[62:63], v4 offset:62464
  ds_read_b64_tr_b16 v[64:65], v5 offset:61440
  ds_read_b64_tr_b16 v[66:67], v5 offset:62464
  s_waitcnt lgkmcnt(11)
  v_mfma_f32_32x32x16_bf16 v[128:143], v[40:43], v[28:31], v[128:143]
  s_waitcnt lgkmcnt(9)
  v_mfma_f32_32x32x16_bf16 v[144:159], v[44:47], v[28:31], v[144:159]
  s_cmp_eq_u32 s48, 2
  s_cbranch_scc0 Ls_9
  v_mfma_f32_16x16x32_bf16 v[68:71], v[20:23], v[32:35], v[68:71]
  v_mfma_f32_16x16x32_bf16 v[72:75], v[20:23], v[36:39], v[72:75]
  v_mfma_f32_16x16x32_bf16 v[76:79], v[20:23], v[40:43], v[76:79]
  v_mfma_f32_16x16x32_bf16 v[80:83], v[20:23], v[44:47], v[80:83]
Ls_9:
  s_waitcnt lgkmcnt(0)
  s_barrier
  s_lshl_b32 s62, s12, 7
  s_lshl_b32 s63, s13, 2
  s_add_u32 s62, s62, s63
  s_add_u32 s62, s62, 49152
  s_cmp_lt_u32 s60, 144
  s_cselect_b32 s62, s62, 0x7fff0000
  s_waitcnt vmcnt(0)
  v_mov_b32 v84, 158216
  v_mov_b32 v85, 1
  s_mov_b64 exec, 1
  ds_add_rtn_u32 v85, v84, v85
  s_waitcnt lgkmcnt(0)
  v_readfirstlane_b32 s63, v85
  s_nop 0
  s_cmp_eq_u32 s63, 3
  s_cselect_b32 s62, s62, 0x7fff0000
  v_mov_b32 v84, s62
  v_mov_b32 v85, s51
  buffer_store_dword v85, v84, s[36:39], 0 offen sc1
  s_mov_b64 exec, -1
  v_mfma_f32_32x32x16_bf16 v[96:111], v[52:55], v[48:51], v[96:111]
  ds_read_b128 v[28:31], v14 offset:0
  ds_read_b64_tr_b16 v[32:33], v6 offset:16384
  ds_read_b64_tr_b16 v[34:35], v6 offset:17408
  ds_read_b64_tr_b16 v[36:37], v7 offset:16384
  ds_read_b64_tr_b16 v[38:39], v7 offset:17408
  v_mfma_f32_32x32x16_bf16 v[112:127], v[56:59], v[48:51], v[112:127]
  ds_read_b64_tr_b16 v[40:41], v8 offset:16384
  ds_read_b64_tr_b16 v[42:43], v8 offset:17408
  ds_read_b64_tr_b16 v[44:45], v9 offset:16384
  ds_read_b64_tr_b16 v[46:47], v9 offset:17408
  v_mfma_f32_32x32x16_bf16 v[128:143], v[60:63], v[48:51], v[128:143]
  v_mfma_f32_32x32x16_bf16 v[144:159], v[64:67], v[48:51], v[144:159]
  s_cmp_eq_u32 s48, 3
  s_cbranch_scc0 Ls_11
  v_mfma_f32_16x16x32_bf16 v[68:71], v[20:23], v[52:55], v[68:71]
  v_mfma_f32_16x16x32_bf16 v[72:75], v[20:23], v[56:59], v[72:75]
  v_mfma_f32_16x16x32_bf16 v[76:79], v[20:23], v[60:63], v[76:79]
  v_mfma_f32_16x16x32_bf16 v[80:83], v[20:23], v[64:67], v[80:83]
Ls_11:
  s_waitcnt lgkmcnt(6)
  v_mfma_f32_32x32x16_bf16 v[96:111], v[32:35], v[28:31], v[96:111]
  ds_read_b128 v[48:51], v15 offset:0
  ds_read_b64_tr_b16 v[52:53], v6 offset:20480
  ds_read_b64_tr_b16 v[54:55], v6 offset:21504
  ds_read_b64_tr_b16 v[56:57], v7 offset:20480
  ds_read_b64_tr_b16 v[58:59], v7 offset:21504
  s_waitcnt lgkmcnt(9)
  v_mfma_f32_32x32x16_bf16 v[112:127], v[36:39], v[28:31], v[112:127]
  ds_read_b64_tr_b16 v[60:61], v8 offset:20480
  ds_read_b64_tr_b16 v[62:63], v8 offset:21504
  ds_read_b64_tr_b16 v[64:65], v9 offset:20480
  ds_read_b64_tr_b16 v[66:67], v9 offset:21504
  s_waitcnt lgkmcnt(11)
  v_mfma_f32_32x32x16_bf16 v[128:143], v[40:43], v[28:31], v[128:143]
  s_waitcnt lgkmcnt(9)
  v_mfma_f32_32x32x16_bf16 v[144:159], v[44:47], v[28:31], v[144:159]
  s_cmp_eq_u32 s48, 0
  s_cbranch_scc0 Ls_12
  v_mfma_f32_16x16x32_bf16 v[68:71], v[20:23], v[32:35], v[68:71]
  v_mfma_f32_16x16x32_bf16 v[72:75], v[20:23], v[36:39], v[72:75]
  v_mfma_f32_16x16x32_bf16 v[76:79], v[20:23], v[40:43], v[76:79]
  v_mfma_f32_16x16x32_bf16 v[80:83], v[20:23], v[44:47], v[80:83]
Ls_12:
  s_waitcnt lgkmcnt(6)
  v_mfma_f32_32x32x16_bf16 v[96:111], v[52:55], v[48:51], v[96:111]
  ds_read_b128 v[28:31], v16 offset:0
  ds_read_b64_tr_b16 v[32:33], v6 offset:24576
  ds_read_b64_tr_b16 v[34:35], v6 offset:25600
  ds_read_b64_tr_b16 v[36:37], v7 offset:24576
  ds_read_b64_tr_b16 v[38:39], v7 offset:25600
  s_waitcnt lgkmcnt(9)
  v_mfma_f32_32x32x16_bf16 v[112:127], v[56:59], v[48:51], v[112:127]
  ds_read_b64_tr_b16 v[40:41], v8 offset:24576
  ds_read_b64_tr_b16 v[42:43], v8 offset:25600
  ds_read_b64_tr_b16 v[44:45], v9 offset:24576
  ds_read_b64_tr_b16 v[46:47], v9 offset:25600
  s_waitcnt lgkmcnt(11)
  v_mfma_f32_32x32x16_bf16 v[128:143], v[60:63], v[48:51], v[128:143]
  s_waitcnt lgkmcnt(9)
  v_mfma_f32_32x32x16_bf16 v[144:159], v[64:67], v[48:51], v[144:159]
  s_cmp_eq_u32 s48, 1
  s_cbranch_scc0 Ls_13
  v_mfma_f32_16x16x32_bf16 v[68:71], v[20:23], v[52:55], v[68:71]
  v_mfma_f32_16x16x32_bf16 v[72:75], v[20:23], v[56:59], v[72:75]
  v_mfma_f32_16x16x32_bf16 v[76:79], v[20:23], v[60:63], v[76:79]
  v_mfma_f32_16x16x32_bf16 v[80:83], v[20:23], v[64:67], v[80:83]
Ls_13:
  s_waitcnt lgkmcnt(6)
  v_mfma_f32_32x32x16_bf16 v[96:111], v[32:35], v[28:31], v[96:111]
  ds_read_b128 v[48:51], v17 offset:0
  ds_read_b64_tr_b16 v[52:53], v6 offset:28672
  ds_read_b64_tr_b16 v[54:55], v6 offset:29696
  ds_read_b64_tr_b16 v[56:57], v7 offset:28672
  ds_read_b64_tr_b16 v[58:59], v7 offset:29696
  s_waitcnt lgkmcnt(9)
  v_mfma_f32_32x32x16_bf16 v[112:127], v[36:39], v[28:31], v[112:127]
  ds_read_b64_tr_b16 v[60:61], v8 offset:28672
  ds_read_b64_tr_b16 v[62:63], v8 offset:29696
  ds_read_b64_tr_b16 v[64:65], v9 offset:28672
  ds_read_b64_tr_b16 v[66:67], v9 offset:29696
  s_waitcnt lgkmcnt(11)
  v_mfma_f32_32x32x16_bf16 v[128:143], v[40:43], v[28:31], v[128:143]
  s_waitcnt lgkmcnt(9)
  v_mfma_f32_32x32x16_bf16 v[144:159], v[44:47], v[28:31], v[144:159]
  s_cmp_eq_u32 s48, 2
  s_cbranch_scc0 Ls_14
  v_mfma_f32_16x16x32_bf16 v[68:71], v[20:23], v[32:35], v[68:71]
  v_mfma_f32_16x16x32_bf16 v[72:75], v[20:23], v[36:39], v[72:75]
  v_mfma_f32_16x16x32_bf16 v[76:79], v[20:23], v[40:43], v[76:79]
  v_mfma_f32_16x16x32_bf16 v[80:83], v[20:23], v[44:47], v[80:83]
Ls_14:
  s_waitcnt lgkmcnt(0)
  s_barrier
  v_mfma_f32_32x32x16_bf16 v[96:111], v[52:55], v[48:51], v[96:111]
  ds_read_b128 v[28:31], v14 offset:32768
  ds_read_b64_tr_b16 v[32:33], v6 offset:49152
  ds_read_b64_tr_b16 v[34:35], v6 offset:50176
  ds_read_b64_tr_b16 v[36:37], v7 offset:49152
  ds_read_b64_tr_b16 v[38:39], v7 offset:50176
  v_mfma_f32_32x32x16_bf16 v[112:127], v[56:59], v[48:51], v[112:127]
  ds_read_b64_tr_b16 v[40:41], v8 offset:49152
  ds_read_b64_tr_b16 v[42:43], v8 offset:50176
  ds_read_b64_tr_b16 v[44:45], v9 offset:49152
  ds_read_b64_tr_b16 v[46:47], v9 offset:50176
  v_mfma_f32_32x32x16_bf16 v[128:143], v[60:63], v[48:51], v[128:143]
  v_mfma_f32_32x32x16_bf16 v[144:159], v[64:67], v[48:51], v[144:159]
  s_cmp_eq_u32 s48, 3
  s_cbranch_scc0 Ls_15
  v_mfma_f32_16x16x32_bf16 v[68:71], v[20:23], v[52:55], v[68:71]
  v_mfma_f32_16x16x32_bf16 v[72:75], v[20:23], v[56:59], v[72:75]
  v_mfma_f32_16x16x32_bf16 v[76:79], v[20:23], v[60:63], v[76:79]
  v_mfma_f32_16x16x32_bf16 v[80:83], v[20:23], v[64:67], v[80:83]
Ls_15:
  s_waitcnt lgkmcnt(6)
  v_mfma_f32_32x32x16_bf16 v[96:111], v[32:35], v[28:31], v[96:111]
  ds_read_b128 v[48:51], v15 offset:32768
  ds_read_b64_tr_b16 v[52:53], v6 offset:53248
  ds_read_b64_tr_b16 v[54:55], v6 offset:54272
  ds_read_b64_tr_b16 v[56:57], v7 offset:53248
  ds_read_b64_tr_b16 v[58:59], v7 offset:54272
  s_waitcnt lgkmcnt(9)
  v_mfma_f32_32x32x16_bf16 v[112:127], v[36:39], v[28:31], v[112:127]
  ds_read_b64_tr_b16 v[60:61], v8 offset:53248
  ds_read_b64_tr_b16 v[62:63], v8 offset:54272
  ds_read_b64_tr_b16 v[64:65], v9 offset:53248
  ds_read_b64_tr_b16 v[66:67], v9 offset:54272
  s_waitcnt lgkmcnt(11)
  v_mfma_f32_32x32x16_bf16 v[128:143], v[40:43], v[28:31], v[128:143]
  s_waitcnt lgkmcnt(9)
  v_mfma_f32_32x32x16_bf16 v[144:159], v[44:47], v[28:31], v[144:159]
  s_cmp_eq_u32 s48, 0
  s_cbranch_scc0 Ls_16
  v_mfma_f32_16x16x32_bf16 v[68:71], v[20:23], v[32:35], v[68:71]
  v_mfma_f32_16x16x32_bf16 v[72:75], v[20:23], v[36:39], v[72:75]
  v_mfma_f32_16x16x32_bf16 v[76:79], v[20:23], v[40:43], v[76:79]
  v_mfma_f32_16x16x32_bf16 v[80:83], v[20:23], v[44:47], v[80:83]
Ls_16:
  s_waitcnt lgkmcnt(6)
  v_mfma_f32_32x32x16_bf16 v[96:111], v[52:55], v[48:51], v[96:111]
  ds_read_b128 v[28:31], v16 offset:32768
  ds_read_b64_tr_b16 v[32:33], v6 offset:57344
  ds_read_b64_tr_b16 v[34:35], v6 offset:58368
  ds_read_b64_tr_b16 v[36:37], v7 offset:57344
  ds_read_b64_tr_b16 v[38:39], v7 offset:58368
  s_waitcnt lgkmcnt(9)
  v_mfma_f32_32x32x16_bf16 v[112:127], v[56:59], v[48:51], v[112:127]
  ds_read_b64_tr_b16 v[40:41], v8 offset:57344
  ds_read_b64_tr_b16 v[42:43], v8 offset:58368
  ds_read_b64_tr_b16 v[44:45], v9 offset:57344
  ds_read_b64_tr_b16 v[46:47], v9 offset:58368
  s_waitcnt lgkmcnt(11)
  v_mfma_f32_32x32x16_bf16 v[128:143], v[60:63], v[48:51], v[128:143]
  s_waitcnt lgkmcnt(9)
  v_mfma_f32_32x32x16_bf16 v[144:159], v[64:67], v[48:51], v[144:159]
  s_cmp_eq_u32 s48, 1
  s_cbranch_scc0 Ls_17
  v_mfma_f32_16x16x32_bf16 v[68:71], v[20:23], v[52:55], v[68:71]
  v_mfma_f32_16x16x32_bf16 v[72:75], v[20:23], v[56:59], v[72:75]
  v_mfma_f32_16x16x32_bf16 v[76:79], v[20:23], v[60:63], v[76:79]
  v_mfma_f32_16x16x32_bf16 v[80:83], v[20:23], v[64:67], v[80:83]
Ls_17:
  s_waitcnt lgkmcnt(6)
  v_mfma_f32_32x32x16_bf16 v[96:111], v[32:35], v[28:31], v[96:111]
  ds_read_b128 v[48:51], v17 offset:32768
  ds_read_b64_tr_b16 v[52:53], v6 offset:61440
  ds_read_b64_tr_b16 v[54:55], v6 offset:62464
  ds_read_b64_tr_b16 v[56:57], v7 offset:61440
  ds_read_b64_tr_b16 v[58:59], v7 offset:62464
  s_waitcnt lgkmcnt(9)
  v_mfma_f32_32x32x16_bf16 v[112:127], v[36:39], v[28:31], v[112:127]
  ds_read_b64_tr_b16 v[60:61], v8 offset:61440
  ds_read_b64_tr_b16 v[62:63], v8 offset:62464
  ds_read_b64_tr_b16 v[64:65], v9 offset:61440
  ds_read_b64_tr_b16 v[66:67], v9 offset:62464
  s_waitcnt lgkmcnt(11)
  v_mfma_f32_32x32x16_bf16 v[128:143], v[40:43], v[28:31], v[128:143]
  s_waitcnt lgkmcnt(9)
  v_mfma_f32_32x32x16_bf16 v[144:159], v[44:47], v[28:31], v[144:159]
  s_cmp_eq_u32 s48, 2
  s_cbranch_scc0 Ls_18
  v_mfma_f32_16x16x32_bf16 v[68:71], v[20:23], v[32:35], v[68:71]
  v_mfma_f32_16x16x32_bf16 v[72:75], v[20:23], v[36:39], v[72:75]
  v_mfma_f32_16x16x32_bf16 v[76:79], v[20:23], v[40:43], v[76:79]
  v_mfma_f32_16x16x32_bf16 v[80:83], v[20:23], v[44:47], v[80:83]
Ls_18:
  s_waitcnt lgkmcnt(0)
  s_barrier
  v_mfma_f32_32x32x16_bf16 v[96:111], v[52:55], v[48:51], v[96:111]
  ds_read_b128 v[28:31], v10 offset:0
  ds_read_b64_tr_b16 v[32:33], v2 offset:16384
  ds_read_b64_tr_b16 v[34:35], v2 offset:17408
  ds_read_b64_tr_b16 v[36:37], v3 offset:16384
  ds_read_b64_tr_b16 v[38:39], v3 offset:17408
  v_mfma_f32_32x32x16_bf16 v[112:127], v[56:59], v[48:51], v[112:127]
  ds_read_b64_tr_b16 v[40:41], v4 offset:16384
  ds_read_b64_tr_b16 v[42:43], v4 offset:17408
  ds_read_b64_tr_b16 v[44:45], v5 offset:16384
  ds_read_b64_tr_b16 v[46:47], v5 offset:17408
  v_mfma_f32_32x32x16_bf16 v[128:143], v[60:63], v[48:51], v[128:143]
  v_mfma_f32_32x32x16_bf16 v[144:159], v[64:67], v[48:51], v[144:159]
  s_cmp_eq_u32 s48, 3
  s_cbranch_scc0 Ls_19
  v_mfma_f32_16x16x32_bf16 v[68:71], v[20:23], v[52:55], v[68:71]
  v_mfma_f32_16x16x32_bf16 v[72:75], v[20:23], v[56:59], v[72:75]
  v_mfma_f32_16x16x32_bf16 v[76:79], v[20:23], v[60:63], v[76:79]
  v_mfma_f32_16x16x32_bf16 v[80:83], v[20:23], v[64:67], v[80:83]
Ls_19:
  s_waitcnt lgkmcnt(6)
  v_mfma_f32_32x32x16_bf16 v[96:111], v[32:35], v[28:31], v[96:111]
  ds_read_b128 v[48:51], v11 offset:0
  ds_read_b64_tr_b16 v[52:53], v2 offset:20480
  ds_read_b64_tr_b16 v[54:55], v2 offset:21504
  ds_read_b64_tr_b16 v[56:57], v3 offset:20480
  ds_read_b64_tr_b16 v[58:59], v3 offset:21504
  s_waitcnt lgkmcnt(9)
  v_mfma_f32_32x32x16_bf16 v[112:127], v[36:39], v[28:31], v[112:127]
  ds_read_b64_tr_b16 v[60:61], v4 offset:20480
  ds_read_b64_tr_b16 v[62:63], v4 offset:21504
  ds_read_b64_tr_b16 v[64:65], v5 offset:20480
  ds_read_b64_tr_b16 v[66:67], v5 offset:21504
  s_waitcnt lgkmcnt(11)
  v_mfma_f32_32x32x16_bf16 v[128:143], v[40:43], v[28:31], v[128:143]
  s_waitcnt lgkmcnt(9)
  v_mfma_f32_32x32x16_bf16 v[144:159], v[44:47], v[28:31], v[144:159]
  s_cmp_eq_u32 s48, 0
  s_cbranch_scc0 Ls_20
  v_mfma_f32_16x16x32_bf16 v[68:71], v[20:23], v[32:35], v[68:71]
  v_mfma_f32_16x16x32_bf16 v[72:75], v[20:23], v[36:39], v[72:75]
  v_mfma_f32_16x16x32_bf16 v[76:79], v[20:23], v[40:43], v[76:79]
  v_mfma_f32_16x16x32_bf16 v[80:83], v[20:23], v[44:47], v[80:83]
Ls_20:
  s_waitcnt lgkmcnt(6)
  v_mfma_f32_32x32x16_bf16 v[96:111], v[52:55], v[48:51], v[96:111]
  ds_read_b128 v[28:31], v12 offset:0
  ds_read_b64_tr_b16 v[32:33], v2 offset:24576
  ds_read_b64_tr_b16 v[34:35], v2 offset:25600
  ds_read_b64_tr_b16 v[36:37], v3 offset:24576
  ds_read_b64_tr_b16 v[38:39], v3 offset:25600
  s_waitcnt lgkmcnt(9)
  v_mfma_f32_32x32x16_bf16 v[112:127], v[56:59], v[48:51], v[112:127]
  ds_read_b64_tr_b16 v[40:41], v4 offset:24576
  ds_read_b64_tr_b16 v[42:43], v4 offset:25600
  ds_read_b64_tr_b16 v[44:45], v5 offset:24576
  ds_read_b64_tr_b16 v[46:47], v5 offset:25600
  s_waitcnt lgkmcnt(11)
  v_mfma_f32_32x32x16_bf16 v[128:143], v[60:63], v[48:51], v[128:143]
  s_waitcnt lgkmcnt(9)
  v_mfma_f32_32x32x16_bf16 v[144:159], v[64:67], v[48:51], v[144:159]
  s_cmp_eq_u32 s48, 1
  s_cbranch_scc0 Ls_21
  v_mfma_f32_16x16x32_bf16 v[68:71], v[20:23], v[52:55], v[68:71]
  v_mfma_f32_16x16x32_bf16 v[72:75], v[20:23], v[56:59], v[72:75]
  v_mfma_f32_16x16x32_bf16 v[76:79], v[20:23], v[60:63], v[76:79]
  v_mfma_f32_16x16x32_bf16 v[80:83], v[20:23], v[64:67], v[80:83]
Ls_21:
  s_waitcnt lgkmcnt(6)
  v_mfma_f32_32x32x16_bf16 v[96:111], v[32:35], v[28:31], v[96:111]
  ds_read_b128 v[48:51], v13 offset:0
  ds_read_b64_tr_b16 v[52:53], v2 offset:28672
  ds_read_b64_tr_b16 v[54:55], v2 offset:29696
  ds_read_b64_tr_b16 v[56:57], v3 offset:28672
  ds_read_b64_tr_b16 v[58:59], v3 offset:29696
  s_waitcnt lgkmcnt(9)
  v_mfma_f32_32x32x16_bf16 v[112:127], v[36:39], v[28:31], v[112:127]
  ds_read_b64_tr_b16 v[60:61], v4 offset:28672
  ds_read_b64_tr_b16 v[62:63], v4 offset:29696
  ds_read_b64_tr_b16 v[64:65], v5 offset:28672
  ds_read_b64_tr_b16 v[66:67], v5 offset:29696
  s_waitcnt lgkmcnt(11)
  v_mfma_f32_32x32x16_bf16 v[128:143], v[40:43], v[28:31], v[128:143]
  s_waitcnt lgkmcnt(9)
  v_mfma_f32_32x32x16_bf16 v[144:159], v[44:47], v[28:31], v[144:159]
  s_cmp_eq_u32 s48, 2
  s_cbranch_scc0 Ls_22
  v_mfma_f32_16x16x32_bf16 v[68:71], v[20:23], v[32:35], v[68:71]
  v_mfma_f32_16x16x32_bf16 v[72:75], v[20:23], v[36:39], v[72:75]
  v_mfma_f32_16x16x32_bf16 v[76:79], v[20:23], v[40:43], v[76:79]
  v_mfma_f32_16x16x32_bf16 v[80:83], v[20:23], v[44:47], v[80:83]
Ls_22:
  s_waitcnt lgkmcnt(0)
  s_barrier
  v_mfma_f32_32x32x16_bf16 v[96:111], v[52:55], v[48:51], v[96:111]
  ds_read_b128 v[28:31], v10 offset:32768
  ds_read_b64_tr_b16 v[32:33], v2 offset:49152
  ds_read_b64_tr_b16 v[34:35], v2 offset:50176
  ds_read_b64_tr_b16 v[36:37], v3 offset:49152
  ds_read_b64_tr_b16 v[38:39], v3 offset:50176
  v_mfma_f32_32x32x16_bf16 v[112:127], v[56:59], v[48:51], v[112:127]
  ds_read_b64_tr_b16 v[40:41], v4 offset:49152
  ds_read_b64_tr_b16 v[42:43], v4 offset:50176
  ds_read_b64_tr_b16 v[44:45], v5 offset:49152
  ds_read_b64_tr_b16 v[46:47], v5 offset:50176
  v_mfma_f32_32x32x16_bf16 v[128:143], v[60:63], v[48:51], v[128:143]
  v_mfma_f32_32x32x16_bf16 v[144:159], v[64:67], v[48:51], v[144:159]
  s_cmp_eq_u32 s48, 3
  s_cbranch_scc0 Ls_23
  v_mfma_f32_16x16x32_bf16 v[68:71], v[20:23], v[52:55], v[68:71]
  v_mfma_f32_16x16x32_bf16 v[72:75], v[20:23], v[56:59], v[72:75]
  v_mfma_f32_16x16x32_bf16 v[76:79], v[20:23], v[60:63], v[76:79]
  v_mfma_f32_16x16x32_bf16 v[80:83], v[20:23], v[64:67], v[80:83]
Ls_23:
  s_waitcnt lgkmcnt(6)
  v_mfma_f32_32x32x16_bf16 v[96:111], v[32:35], v[28:31], v[96:111]
  ds_read_b128 v[48:51], v11 offset:32768
  ds_read_b64_tr_b16 v[52:53], v2 offset:53248
  ds_read_b64_tr_b16 v[54:55], v2 offset:54272
  ds_read_b64_tr_b16 v[56:57], v3 offset:53248
  ds_read_b64_tr_b16 v[58:59], v3 offset:54272
  s_waitcnt lgkmcnt(9)
  v_mfma_f32_32x32x16_bf16 v[112:127], v[36:39], v[28:31], v[112:127]
  ds_read_b64_tr_b16 v[60:61], v4 offset:53248
  ds_read_b64_tr_b16 v[62:63], v4 offset:54272
  ds_read_b64_tr_b16 v[64:65], v5 offset:53248
  ds_read_b64_tr_b16 v[66:67], v5 offset:54272
  s_waitcnt lgkmcnt(11)
  v_mfma_f32_32x32x16_bf16 v[128:143], v[40:43], v[28:31], v[128:143]
  s_waitcnt lgkmcnt(9)
  v_mfma_f32_32x32x16_bf16 v[144:159], v[44:47], v[28:31], v[144:159]
  s_cmp_eq_u32 s48, 0
  s_cbranch_scc0 Ls_24
  v_mfma_f32_16x16x32_bf16 v[68:71], v[20:23], v[32:35], v[68:71]
  v_mfma_f32_16x16x32_bf16 v[72:75], v[20:23], v[36:39], v[72:75]
  v_mfma_f32_16x16x32_bf16 v[76:79], v[20:23], v[40:43], v[76:79]
  v_mfma_f32_16x16x32_bf16 v[80:83], v[20:23], v[44:47], v[80:83]
Ls_24:
  s_waitcnt lgkmcnt(6)
  v_mfma_f32_32x32x16_bf16 v[96:111], v[52:55], v[48:51], v[96:111]
  ds_read_b128 v[28:31], v12 offset:32768
  ds_read_b64_tr_b16 v[32:33], v2 offset:57344
  ds_read_b64_tr_b16 v[34:35], v2 offset:58368
  ds_read_b64_tr_b16 v[36:37], v3 offset:57344
  ds_read_b64_tr_b16 v[38:39], v3 offset:58368
  s_waitcnt lgkmcnt(9)
  v_mfma_f32_32x32x16_bf16 v[112:127], v[56:59], v[48:51], v[112:127]
  ds_read_b64_tr_b16 v[40:41], v4 offset:57344
  ds_read_b64_tr_b16 v[42:43], v4 offset:58368
  ds_read_b64_tr_b16 v[44:45], v5 offset:57344
  ds_read_b64_tr_b16 v[46:47], v5 offset:58368
  s_waitcnt lgkmcnt(11)
  v_mfma_f32_32x32x16_bf16 v[128:143], v[60:63], v[48:51], v[128:143]
  s_waitcnt lgkmcnt(9)
  v_mfma_f32_32x32x16_bf16 v[144:159], v[64:67], v[48:51], v[144:159]
  s_cmp_eq_u32 s48, 1
  s_cbranch_scc0 Ls_25
  v_mfma_f32_16x16x32_bf16 v[68:71], v[20:23], v[52:55], v[68:71]
  v_mfma_f32_16x16x32_bf16 v[72:75], v[20:23], v[56:59], v[72:75]
  v_mfma_f32_16x16x32_bf16 v[76:79], v[20:23], v[60:63], v[76:79]
  v_mfma_f32_16x16x32_bf16 v[80:83], v[20:23], v[64:67], v[80:83]
Ls_25:
  s_waitcnt lgkmcnt(6)
  v_mfma_f32_32x32x16_bf16 v[96:111], v[32:35], v[28:31], v[96:111]
  ds_read_b128 v[48:51], v13 offset:32768
  ds_read_b64_tr_b16 v[52:53], v2 offset:61440
  ds_read_b64_tr_b16 v[54:55], v2 offset:62464
  ds_read_b64_tr_b16 v[56:57], v3 offset:61440
  ds_read_b64_tr_b16 v[58:59], v3 offset:62464
  s_waitcnt lgkmcnt(9)
  v_mfma_f32_32x32x16_bf16 v[112:127], v[36:39], v[28:31], v[112:127]
  ds_read_b64_tr_b16 v[60:61], v4 offset:61440
  ds_read_b64_tr_b16 v[62:63], v4 offset:62464
  ds_read_b64_tr_b16 v[64:65], v5 offset:61440
  ds_read_b64_tr_b16 v[66:67], v5 offset:62464
  s_waitcnt lgkmcnt(11)
  v_mfma_f32_32x32x16_bf16 v[128:143], v[40:43], v[28:31], v[128:143]
  s_waitcnt lgkmcnt(9)
  v_mfma_f32_32x32x16_bf16 v[144:159], v[44:47], v[28:31], v[144:159]
  s_cmp_eq_u32 s48, 2
  s_cbranch_scc0 Ls_26
  v_mfma_f32_16x16x32_bf16 v[68:71], v[20:23], v[32:35], v[68:71]
  v_mfma_f32_16x16x32_bf16 v[72:75], v[20:23], v[36:39], v[72:75]
  v_mfma_f32_16x16x32_bf16 v[76:79], v[20:23], v[40:43], v[76:79]
  v_mfma_f32_16x16x32_bf16 v[80:83], v[20:23], v[44:47], v[80:83]
Ls_26:
  s_waitcnt lgkmcnt(0)
  s_barrier
  v_mfma_f32_32x32x16_bf16 v[96:111], v[52:55], v[48:51], v[96:111]
  ds_read_b128 v[28:31], v14 offset:0
  ds_read_b64_tr_b16 v[32:33], v6 offset:16384
  ds_read_b64_tr_b16 v[34:35], v6 offset:17408
  ds_read_b64_tr_b16 v[36:37], v7 offset:16384
  ds_read_b64_tr_b16 v[38:39], v7 offset:17408
  v_mfma_f32_32x32x16_bf16 v[112:127], v[56:59], v[48:51], v[112:127]
  ds_read_b64_tr_b16 v[40:41], v8 offset:16384
  ds_read_b64_tr_b16 v[42:43], v8 offset:17408
  ds_read_b64_tr_b16 v[44:45], v9 offset:16384
  ds_read_b64_tr_b16 v[46:47], v9 offset:17408
  v_mfma_f32_32x32x16_bf16 v[128:143], v[60:63], v[48:51], v[128:143]
  v_mfma_f32_32x32x16_bf16 v[144:159], v[64:67], v[48:51], v[144:159]
  s_cmp_eq_u32 s48, 3
  s_cbranch_scc0 Ls_27
  v_mfma_f32_16x16x32_bf16 v[68:71], v[20:23], v[52:55], v[68:71]
  v_mfma_f32_16x16x32_bf16 v[72:75], v[20:23], v[56:59], v[72:75]
  v_mfma_f32_16x16x32_bf16 v[76:79], v[20:23], v[60:63], v[76:79]
  v_mfma_f32_16x16x32_bf16 v[80:83], v[20:23], v[64:67], v[80:83]
Ls_27:
  s_waitcnt lgkmcnt(6)
  v_mfma_f32_32x32x16_bf16 v[96:111], v[32:35], v[28:31], v[96:111]
  ds_read_b128 v[48:51], v15 offset:0
  ds_read_b64_tr_b16 v[52:53], v6 offset:20480
  ds_read_b64_tr_b16 v[54:55], v6 offset:21504
  ds_read_b64_tr_b16 v[56:57], v7 offset:20480
  ds_read_b64_tr_b16 v[58:59], v7 offset:21504
  s_waitcnt lgkmcnt(9)
  v_mfma_f32_32x32x16_bf16 v[112:127], v[36:39], v[28:31], v[112:127]
  ds_read_b64_tr_b16 v[60:61], v8 offset:20480
  ds_read_b64_tr_b16 v[62:63], v8 offset:21504
  ds_read_b64_tr_b16 v[64:65], v9 offset:20480
  ds_read_b64_tr_b16 v[66:67], v9 offset:21504
  s_waitcnt lgkmcnt(11)
  v_mfma_f32_32x32x16_bf16 v[128:143], v[40:43], v[28:31], v[128:143]
  s_waitcnt lgkmcnt(9)
  v_mfma_f32_32x32x16_bf16 v[144:159], v[44:47], v[28:31], v[144:159]
  s_cmp_eq_u32 s48, 0
  s_cbranch_scc0 Ls_28
  v_mfma_f32_16x16x32_bf16 v[68:71], v[20:23], v[32:35], v[68:71]
  v_mfma_f32_16x16x32_bf16 v[72:75], v[20:23], v[36:39], v[72:75]
  v_mfma_f32_16x16x32_bf16 v[76:79], v[20:23], v[40:43], v[76:79]
  v_mfma_f32_16x16x32_bf16 v[80:83], v[20:23], v[44:47], v[80:83]
Ls_28:
  s_waitcnt lgkmcnt(6)
  v_mfma_f32_32x32x16_bf16 v[96:111], v[52:55], v[48:51], v[96:111]
  ds_read_b128 v[28:31], v16 offset:0
  ds_read_b64_tr_b16 v[32:33], v6 offset:24576
  ds_read_b64_tr_b16 v[34:35], v6 offset:25600
  ds_read_b64_tr_b16 v[36:37], v7 offset:24576
  ds_read_b64_tr_b16 v[38:39], v7 offset:25600
  s_waitcnt lgkmcnt(9)
  v_mfma_f32_32x32x16_bf16 v[112:127], v[56:59], v[48:51], v[112:127]
  ds_read_b64_tr_b16 v[40:41], v8 offset:24576
  ds_read_b64_tr_b16 v[42:43], v8 offset:25600
  ds_read_b64_tr_b16 v[44:45], v9 offset:24576
  ds_read_b64_tr_b16 v[46:47], v9 offset:25600
  s_waitcnt lgkmcnt(11)
  v_mfma_f32_32x32x16_bf16 v[128:143], v[60:63], v[48:51], v[128:143]
  ds_read_b64_tr_b16 v[160:161], v19 offset:0
  ds_read_b64_tr_b16 v[162:163], v19 offset:256
  ds_read_b64_tr_b16 v[164:165], v19 offset:32
  ds_read_b64_tr_b16 v[166:167], v19 offset:288
  ds_read_b64_tr_b16 v[168:169], v19 offset:512
  ds_read_b64_tr_b16 v[170:171], v19 offset:768
  s_waitcnt lgkmcnt(15)
  v_mfma_f32_32x32x16_bf16 v[144:159], v[64:67], v[48:51], v[144:159]
  ds_read_b64_tr_b16 v[172:173], v19 offset:544
  ds_read_b64_tr_b16 v[174:175], v19 offset:800
  ds_read_b64_tr_b16 v[176:177], v19 offset:1024
  ds_read_b64_tr_b16 v[178:179], v19 offset:1280
  ds_read_b64_tr_b16 v[180:181], v19 offset:1056
  ds_read_b64_tr_b16 v[182:183], v19 offset:1312
  s_cmp_eq_u32 s48, 1
  s_cbranch_scc0 Ls_29
  v_mfma_f32_16x16x32_bf16 v[68:71], v[20:23], v[52:55], v[68:71]
  v_mfma_f32_16x16x32_bf16 v[72:75], v[20:23], v[56:59], v[72:75]
  v_mfma_f32_16x16x32_bf16 v[76:79], v[20:23], v[60:63], v[76:79]
  v_mfma_f32_16x16x32_bf16 v[80:83], v[20:23], v[64:67], v[80:83]
Ls_29:
  v_mov_b32 v89, 158252
  s_waitcnt lgkmcnt(15)
  v_mfma_f32_32x32x16_bf16 v[96:111], v[32:35], v[28:31], v[96:111]
  ds_read_b128 v[48:51], v17 offset:0
  ds_read_b64_tr_b16 v[52:53], v6 offset:28672
  ds_read_b64_tr_b16 v[54:55], v6 offset:29696
  ds_read_b64_tr_b16 v[56:57], v7 offset:28672
  ds_read_b64_tr_b16 v[58:59], v7 offset:29696
  v_mfma_f32_32x32x16_bf16 v[112:127], v[36:39], v[28:31], v[112:127]
  ds_read_b64_tr_b16 v[60:61], v8 offset:28672
  ds_read_b64_tr_b16 v[62:63], v8 offset:29696
  ds_read_b64_tr_b16 v[64:65], v9 offset:28672
  ds_read_b64_tr_b16 v[66:67], v9 offset:29696
  s_waitcnt lgkmcnt(15)
  v_mfma_f32_32x32x16_bf16 v[128:143], v[40:43], v[28:31], v[128:143]
  v_mfma_f32_32x32x16_bf16 v[144:159], v[44:47], v[28:31], v[144:159]
  ds_read_b32 v90, v89
  s_cmp_eq_u32 s48, 2
  s_cbranch_scc0 Ls_30
  v_mfma_f32_16x16x32_bf16 v[68:71], v[20:23], v[32:35], v[68:71]
  v_mfma_f32_16x16x32_bf16 v[72:75], v[20:23], v[36:39], v[72:75]
  v_mfma_f32_16x16x32_bf16 v[76:79], v[20:23], v[40:43], v[76:79]
  v_mfma_f32_16x16x32_bf16 v[80:83], v[20:23], v[44:47], v[80:83]
Ls_30:
  s_waitcnt lgkmcnt(0)
  v_readfirstlane_b32 s63, v90
  s_nop 0
  s_cmp_ge_u32 s63, 2
  s_cbranch_scc1 Lck_31
  v_mov_b32 v89, 158252
  s_mov_b64 exec, 1
  s_mov_b32 s59, 0
Lls_32:
  ds_read_b32 v90, v89
  s_add_u32 s59, s59, 1
  s_cmp_ge_u32 s59, 4000000
  s_waitcnt lgkmcnt(0)
  v_readfirstlane_b32 s63, v90
  s_cbranch_scc1 Llsd_33
  s_cmp_lt_u32 s63, 2
  s_cbranch_scc1 Lls_32
Llsd_33:
  s_mov_b64 exec, -1
Lck_31:
  buffer_load_dwordx4 v[24:27], v18, s[36:39], 0 offen sc1
  v_mfma_f32_32x32x16_bf16 v[96:111], v[52:55], v[48:51], v[96:111]
  ds_read_b128 v[28:31], v14 offset:32768
  ds_read_b64_tr_b16 v[32:33], v6 offset:49152
  ds_read_b64_tr_b16 v[34:35], v6 offset:50176
  ds_read_b64_tr_b16 v[36:37], v7 offset:49152
  ds_read_b64_tr_b16 v[38:39], v7 offset:50176
  v_mfma_f32_32x32x16_bf16 v[112:127], v[56:59], v[48:51], v[112:127]
  ds_read_b64_tr_b16 v[40:41], v8 offset:49152
  ds_read_b64_tr_b16 v[42:43], v8 offset:50176
  ds_read_b64_tr_b16 v[44:45], v9 offset:49152
  ds_read_b64_tr_b16 v[46:47], v9 offset:50176
  v_mfma_f32_32x32x16_bf16 v[128:143], v[60:63], v[48:51], v[128:143]
  v_mfma_f32_32x32x16_bf16 v[144:159], v[64:67], v[48:51], v[144:159]
  s_cmp_eq_u32 s48, 3
  s_cbranch_scc0 Ls_34
  v_mfma_f32_16x16x32_bf16 v[68:71], v[20:23], v[52:55], v[68:71]
  v_mfma_f32_16x16x32_bf16 v[72:75], v[20:23], v[56:59], v[72:75]
  v_mfma_f32_16x16x32_bf16 v[76:79], v[20:23], v[60:63], v[76:79]
  v_mfma_f32_16x16x32_bf16 v[80:83], v[20:23], v[64:67], v[80:83]
Ls_34:
  s_waitcnt lgkmcnt(6)
  v_mfma_f32_32x32x16_bf16 v[96:111], v[32:35], v[28:31], v[96:111]
  ds_read_b128 v[48:51], v15 offset:32768
  ds_read_b64_tr_b16 v[52:53], v6 offset:53248
  ds_read_b64_tr_b16 v[54:55], v6 offset:54272
  ds_read_b64_tr_b16 v[56:57], v7 offset:53248
  ds_read_b64_tr_b16 v[58:59], v7 offset:54272
  s_waitcnt lgkmcnt(9)
  v_mfma_f32_32x32x16_bf16 v[112:127], v[36:39], v[28:31], v[112:127]
  ds_read_b64_tr_b16 v[60:61], v8 offset:53248
  ds_read_b64_tr_b16 v[62:63], v8 offset:54272
  ds_read_b64_tr_b16 v[64:65], v9 offset:53248
  ds_read_b64_tr_b16 v[66:67], v9 offset:54272
  s_waitcnt lgkmcnt(11)
  v_mfma_f32_32x32x16_bf16 v[128:143], v[40:43], v[28:31], v[128:143]
  s_waitcnt lgkmcnt(9)
  v_mfma_f32_32x32x16_bf16 v[144:159], v[44:47], v[28:31], v[144:159]
  s_cmp_eq_u32 s48, 0
  s_cbranch_scc0 Ls_35
  v_mfma_f32_16x16x32_bf16 v[68:71], v[20:23], v[32:35], v[68:71]
  v_mfma_f32_16x16x32_bf16 v[72:75], v[20:23], v[36:39], v[72:75]
  v_mfma_f32_16x16x32_bf16 v[76:79], v[20:23], v[40:43], v[76:79]
  v_mfma_f32_16x16x32_bf16 v[80:83], v[20:23], v[44:47], v[80:83]
Ls_35:
  s_waitcnt lgkmcnt(6)
  v_mfma_f32_32x32x16_bf16 v[96:111], v[52:55], v[48:51], v[96:111]
  ds_read_b128 v[28:31], v16 offset:32768
  ds_read_b64_tr_b16 v[32:33], v6 offset:57344
  ds_read_b64_tr_b16 v[34:35], v6 offset:58368
  ds_read_b64_tr_b16 v[36:37], v7 offset:57344
  ds_read_b64_tr_b16 v[38:39], v7 offset:58368
  s_waitcnt lgkmcnt(9)
  v_mfma_f32_32x32x16_bf16 v[112:127], v[56:59], v[48:51], v[112:127]
  ds_read_b64_tr_b16 v[40:41], v8 offset:57344
  ds_read_b64_tr_b16 v[42:43], v8 offset:58368
  ds_read_b64_tr_b16 v[44:45], v9 offset:57344
  ds_read_b64_tr_b16 v[46:47], v9 offset:58368
  s_waitcnt lgkmcnt(11)
  v_mfma_f32_32x32x16_bf16 v[128:143], v[60:63], v[48:51], v[128:143]
  s_waitcnt lgkmcnt(9)
  v_mfma_f32_32x32x16_bf16 v[144:159], v[64:67], v[48:51], v[144:159]
  s_cmp_eq_u32 s48, 1
  s_cbranch_scc0 Ls_36
  v_mfma_f32_16x16x32_bf16 v[68:71], v[20:23], v[52:55], v[68:71]
  v_mfma_f32_16x16x32_bf16 v[72:75], v[20:23], v[56:59], v[72:75]
  v_mfma_f32_16x16x32_bf16 v[76:79], v[20:23], v[60:63], v[76:79]
  v_mfma_f32_16x16x32_bf16 v[80:83], v[20:23], v[64:67], v[80:83]
Ls_36:
  s_waitcnt vmcnt(0)
  s_mov_b32 s59, 0
Lpoll_37:
  v_cmp_ne_u32 vcc, s51, v27
  s_nop 0
  s_cbranch_vccz Lpolld_38
  buffer_load_dwordx4 v[24:27], v18, s[36:39], 0 offen sc1
  s_add_u32 s59, s59, 1
  s_cmp_lt_u32 s59, 200000
  s_waitcnt vmcnt(0)
  s_cbranch_scc1 Lpoll_37
Lpolld_38:
  v_sub_f32 v86, 0, v24
  v_cvt_pk_bf16_f32 v252, v86, v86
  v_lshlrev_b32 v87, 16, v252
  v_sub_f32 v87, v86, v87
  v_mov_b32 v88, 0
  v_cvt_pk_bf16_f32 v253, v87, v88
  v_mov_b32 v254, 0
  v_mov_b32 v255, 0
  v_mov_b32 v238, 0
  v_mov_b32 v239, 0
  v_mov_b32 v242, 0
  v_mov_b32 v243, 0
  v_mov_b32 v246, 0
  v_mov_b32 v247, 0
  v_mov_b32 v250, 0
  v_mov_b32 v251, 0
  v_mov_b32 v89, 158256
  s_waitcnt lgkmcnt(6)
  v_mfma_f32_32x32x16_bf16 v[96:111], v[32:35], v[28:31], v[96:111]
  ds_read_b128 v[48:51], v17 offset:32768
  ds_read_b64_tr_b16 v[52:53], v6 offset:61440
  ds_read_b64_tr_b16 v[54:55], v6 offset:62464
  ds_read_b64_tr_b16 v[56:57], v7 offset:61440
  ds_read_b64_tr_b16 v[58:59], v7 offset:62464
  s_waitcnt lgkmcnt(9)
  v_mfma_f32_32x32x16_bf16 v[112:127], v[36:39], v[28:31], v[112:127]
  ds_read_b64_tr_b16 v[60:61], v8 offset:61440
  ds_read_b64_tr_b16 v[62:63], v8 offset:62464
  ds_read_b64_tr_b16 v[64:65], v9 offset:61440
  ds_read_b64_tr_b16 v[66:67], v9 offset:62464
  s_waitcnt lgkmcnt(11)
  v_mfma_f32_32x32x16_bf16 v[128:143], v[40:43], v[28:31], v[128:143]
  s_waitcnt lgkmcnt(9)
  v_mfma_f32_32x32x16_bf16 v[144:159], v[44:47], v[28:31], v[144:159]
  ds_read_b32 v90, v89
  s_cmp_eq_u32 s48, 2
  s_cbranch_scc0 Ls_39
  v_mfma_f32_16x16x32_bf16 v[68:71], v[20:23], v[32:35], v[68:71]
  v_mfma_f32_16x16x32_bf16 v[72:75], v[20:23], v[36:39], v[72:75]
  v_mfma_f32_16x16x32_bf16 v[76:79], v[20:23], v[40:43], v[76:79]
  v_mfma_f32_16x16x32_bf16 v[80:83], v[20:23], v[44:47], v[80:83]
Ls_39:
  s_waitcnt lgkmcnt(0)
  v_readfirstlane_b32 s63, v90
  s_nop 0
  s_cmp_ge_u32 s63, 2
  s_cbranch_scc1 Lck_40
  v_mov_b32 v89, 158256
  s_mov_b64 exec, 1
  s_mov_b32 s59, 0
Lls_41:
  ds_read_b32 v90, v89
  s_add_u32 s59, s59, 1
  s_cmp_ge_u32 s59, 4000000
  s_waitcnt lgkmcnt(0)
  v_readfirstlane_b32 s63, v90
  s_cbranch_scc1 Llsd_42
  s_cmp_lt_u32 s63, 2
  s_cbranch_scc1 Lls_41
Llsd_42:
  s_mov_b64 exec, -1
Lck_40:
  v_mfma_f32_32x32x16_bf16 v[96:111], v[52:55], v[48:51], v[96:111]
  ds_read_b128 v[28:31], v10 offset:0
  ds_read_b64_tr_b16 v[32:33], v2 offset:16384
  ds_read_b64_tr_b16 v[34:35], v2 offset:17408
  ds_read_b64_tr_b16 v[36:37], v3 offset:16384
  ds_read_b64_tr_b16 v[38:39], v3 offset:17408
  v_mfma_f32_32x32x16_bf16 v[112:127], v[56:59], v[48:51], v[112:127]
  ds_read_b64_tr_b16 v[40:41], v4 offset:16384
  ds_read_b64_tr_b16 v[42:43], v4 offset:17408
  ds_read_b64_tr_b16 v[44:45], v5 offset:16384
  ds_read_b64_tr_b16 v[46:47], v5 offset:17408
  v_mfma_f32_32x32x16_bf16 v[128:143], v[60:63], v[48:51], v[128:143]
  v_mfma_f32_32x32x16_bf16 v[144:159], v[64:67], v[48:51], v[144:159]
  s_cmp_eq_u32 s48, 3
  s_cbranch_scc0 Ls_43
  v_mfma_f32_16x16x32_bf16 v[68:71], v[20:23], v[52:55], v[68:71]
  v_mfma_f32_16x16x32_bf16 v[72:75], v[20:23], v[56:59], v[72:75]
  v_mfma_f32_16x16x32_bf16 v[76:79], v[20:23], v[60:63], v[76:79]
  v_mfma_f32_16x16x32_bf16 v[80:83], v[20:23], v[64:67], v[80:83]
Ls_43:
  v_bfe_u32 v84, v1, 4, 1
  v_cmp_eq_u32 s[24:25], 1, v84
  v_and_b32 v84, 31, v1
  v_lshlrev_b32 v84, 4, v84
  v_add_u32 v219, 135680, v84
  s_lshl_b32 s57, s48, 9
  v_add_u32 v85, s57, v219
  v_cndmask_b32 v220, v68, v69, s[24:25]
  v_cndmask_b32 v221, v72, v73, s[24:25]
  v_cndmask_b32 v222, v76, v77, s[24:25]
  v_cndmask_b32 v223, v80, v81, s[24:25]
  ds_write_b128 v85, v[220:223]
  s_waitcnt lgkmcnt(7)
  v_mfma_f32_32x32x16_bf16 v[96:111], v[32:35], v[28:31], v[96:111]
  ds_read_b128 v[48:51], v11 offset:0
  ds_read_b64_tr_b16 v[52:53], v2 offset:20480
  ds_read_b64_tr_b16 v[54:55], v2 offset:21504
  ds_read_b64_tr_b16 v[56:57], v3 offset:20480
  ds_read_b64_tr_b16 v[58:59], v3 offset:21504
  s_waitcnt lgkmcnt(10)
  v_mfma_f32_32x32x16_bf16 v[112:127], v[36:39], v[28:31], v[112:127]
  ds_read_b64_tr_b16 v[60:61], v4 offset:20480
  ds_read_b64_tr_b16 v[62:63], v4 offset:21504
  ds_read_b64_tr_b16 v[64:65], v5 offset:20480
  ds_read_b64_tr_b16 v[66:67], v5 offset:21504
  s_waitcnt lgkmcnt(12)
  v_mfma_f32_32x32x16_bf16 v[128:143], v[40:43], v[28:31], v[128:143]
  s_waitcnt lgkmcnt(10)
  v_mfma_f32_32x32x16_bf16 v[144:159], v[44:47], v[28:31], v[144:159]
  v_mfma_f32_16x16x32_bf16 v[68:71], v[20:23], v[32:35], 0
  v_mfma_f32_16x16x32_bf16 v[72:75], v[20:23], v[36:39], 0
  v_mfma_f32_16x16x32_bf16 v[76:79], v[20:23], v[40:43], 0
  v_mfma_f32_16x16x32_bf16 v[80:83], v[20:23], v[44:47], 0
  s_waitcnt lgkmcnt(9)
  v_mov_b32 v84, 158264
  v_mov_b32 v85, 1
  s_mov_b64 exec, 1
  ds_add_u32 v84, v85
  s_mov_b64 exec, -1
  s_waitcnt lgkmcnt(7)
  v_mfma_f32_32x32x16_bf16 v[96:111], v[52:55], v[48:51], v[96:111]
  ds_read_b128 v[28:31], v12 offset:0
  ds_read_b64_tr_b16 v[32:33], v2 offset:24576
  ds_read_b64_tr_b16 v[34:35], v2 offset:25600
  ds_read_b64_tr_b16 v[36:37], v3 offset:24576
  ds_read_b64_tr_b16 v[38:39], v3 offset:25600
  s_waitcnt lgkmcnt(10)
  v_mfma_f32_32x32x16_bf16 v[112:127], v[56:59], v[48:51], v[112:127]
  ds_read_b64_tr_b16 v[40:41], v4 offset:24576
  ds_read_b64_tr_b16 v[42:43], v4 offset:25600
  ds_read_b64_tr_b16 v[44:45], v5 offset:24576
  ds_read_b64_tr_b16 v[46:47], v5 offset:25600
  s_waitcnt lgkmcnt(12)
  v_mfma_f32_32x32x16_bf16 v[128:143], v[60:63], v[48:51], v[128:143]
  s_waitcnt lgkmcnt(10)
  v_mfma_f32_32x32x16_bf16 v[144:159], v[64:67], v[48:51], v[144:159]
  v_mfma_f32_16x16x32_bf16 v[68:71], v[20:23], v[52:55], v[68:71]
  v_mfma_f32_16x16x32_bf16 v[72:75], v[20:23], v[56:59], v[72:75]
  v_mfma_f32_16x16x32_bf16 v[76:79], v[20:23], v[60:63], v[76:79]
  v_mfma_f32_16x16x32_bf16 v[80:83], v[20:23], v[64:67], v[80:83]
  v_mov_b32 v89, 158264
  ds_read_b32 v90, v89
  s_waitcnt lgkmcnt(7)
  v_mfma_f32_32x32x16_bf16 v[96:111], v[32:35], v[28:31], v[96:111]
  ds_read_b128 v[48:51], v13 offset:0
  ds_read_b64_tr_b16 v[52:53], v2 offset:28672
  ds_read_b64_tr_b16 v[54:55], v2 offset:29696
  ds_read_b64_tr_b16 v[56:57], v3 offset:28672
  ds_read_b64_tr_b16 v[58:59], v3 offset:29696
  s_waitcnt lgkmcnt(10)
  v_mfma_f32_32x32x16_bf16 v[112:127], v[36:39], v[28:31], v[112:127]
  ds_read_b64_tr_b16 v[60:61], v4 offset:28672
  ds_read_b64_tr_b16 v[62:63], v4 offset:29696
  ds_read_b64_tr_b16 v[64:65], v5 offset:28672
  ds_read_b64_tr_b16 v[66:67], v5 offset:29696
  s_waitcnt lgkmcnt(12)
  v_mfma_f32_32x32x16_bf16 v[128:143], v[40:43], v[28:31], v[128:143]
  s_waitcnt lgkmcnt(10)
  v_mfma_f32_32x32x16_bf16 v[144:159], v[44:47], v[28:31], v[144:159]
  v_mfma_f32_16x16x32_bf16 v[68:71], v[20:23], v[32:35], v[68:71]
  v_mfma_f32_16x16x32_bf16 v[72:75], v[20:23], v[36:39], v[72:75]
  v_mfma_f32_16x16x32_bf16 v[76:79], v[20:23], v[40:43], v[76:79]
  v_mfma_f32_16x16x32_bf16 v[80:83], v[20:23], v[44:47], v[80:83]
  s_waitcnt lgkmcnt(9)
  v_readfirstlane_b32 s63, v90
  s_nop 0
  s_cmp_ge_u32 s63, 4
  s_cbranch_scc1 Lck_44
  v_mov_b32 v89, 158264
  s_mov_b64 exec, 1
  s_mov_b32 s59, 0
Lls_45:
  ds_read_b32 v90, v89
  s_add_u32 s59, s59, 1
  s_cmp_ge_u32 s59, 4000000
  s_waitcnt lgkmcnt(0)
  v_readfirstlane_b32 s63, v90
  s_cbranch_scc1 Llsd_46
  s_cmp_lt_u32 s63, 4
  s_cbranch_scc1 Lls_45
Llsd_46:
  s_mov_b64 exec, -1
Lck_44:
  ds_read_b128 v[200:203], v219 offset:0
  ds_read_b128 v[204:207], v219 offset:512
  ds_read_b128 v[208:211], v219 offset:1024
  ds_read_b128 v[212:215], v219 offset:1536
  s_waitcnt lgkmcnt(10)
  v_mfma_f32_32x32x16_bf16 v[96:111], v[52:55], v[48:51], v[96:111]
  s_waitcnt lgkmcnt(8)
  v_mfma_f32_32x32x16_bf16 v[112:127], v[56:59], v[48:51], v[112:127]
  s_waitcnt lgkmcnt(6)
  v_mfma_f32_32x32x16_bf16 v[128:143], v[60:63], v[48:51], v[128:143]
  s_waitcnt lgkmcnt(4)
  v_mfma_f32_32x32x16_bf16 v[144:159], v[64:67], v[48:51], v[144:159]
  v_mfma_f32_16x16x32_bf16 v[68:71], v[20:23], v[52:55], v[68:71]
  v_mfma_f32_16x16x32_bf16 v[72:75], v[20:23], v[56:59], v[72:75]
  v_mfma_f32_16x16x32_bf16 v[76:79], v[20:23], v[60:63], v[76:79]
  v_mfma_f32_16x16x32_bf16 v[80:83], v[20:23], v[64:67], v[80:83]
  v_mov_b32 v84, 158232
  v_mov_b32 v85, 1
  s_mov_b64 exec, 1
  ds_add_u32 v84, v85
  s_mov_b64 exec, -1
  s_waitcnt lgkmcnt(0)
  v_pk_add_f32 v[200:201], v[200:201], v[204:205]
  v_pk_add_f32 v[208:209], v[208:209], v[212:213]
  v_pk_add_f32 v[202:203], v[202:203], v[206:207]
  v_pk_add_f32 v[210:211], v[210:211], v[214:215]
  v_pk_add_f32 v[200:201], v[200:201], v[208:209]
  v_pk_add_f32 v[202:203], v[202:203], v[210:211]
  v_cmp_gt_u32 vcc, 32, v1
  v_cndmask_b32 v86, v72, v73, s[24:25]
  v_add_f32 v86, v86, v201
  v_cndmask_b32 v86, 0, v86, vcc
  v_cvt_pk_bf16_f32 v241, v86, v88
  v_lshlrev_b32 v87, 16, v241
  v_sub_f32 v87, v86, v87
  v_cvt_pk_bf16_f32 v240, v86, v87
  s_nop 1
  v_mfma_f32_32x32x16_bf16 v[112:127], v[240:243], v[252:255], v[112:127]
  v_cndmask_b32 v86, v80, v81, s[24:25]
  v_add_f32 v86, v86, v203
  v_cndmask_b32 v86, 0, v86, vcc
  v_cvt_pk_bf16_f32 v249, v86, v88
  v_lshlrev_b32 v87, 16, v249
  v_sub_f32 v87, v86, v87
  v_cvt_pk_bf16_f32 v248, v86, v87
  s_nop 1
  v_mfma_f32_32x32x16_bf16 v[144:159], v[248:251], v[252:255], v[144:159]
  v_cndmask_b32 v86, v76, v77, s[24:25]
  v_add_f32 v86, v86, v202
  v_cndmask_b32 v86, 0, v86, vcc
  v_cvt_pk_bf16_f32 v245, v86, v88
  v_lshlrev_b32 v87, 16, v245
  v_sub_f32 v87, v86, v87
  v_cvt_pk_bf16_f32 v244, v86, v87
  s_nop 1
  v_mfma_f32_32x32x16_bf16 v[128:143], v[244:247], v[252:255], v[128:143]
  v_cndmask_b32 v86, v68, v69, s[24:25]
  v_add_f32 v86, v86, v200
  v_cndmask_b32 v86, 0, v86, vcc
  v_cvt_pk_bf16_f32 v237, v86, v88
  v_lshlrev_b32 v87, 16, v237
  v_sub_f32 v87, v86, v87
  v_cvt_pk_bf16_f32 v236, v86, v87
  s_nop 1
  v_mfma_f32_32x32x16_bf16 v[96:111], v[236:239], v[252:255], v[96:111]
  v_cvt_pk_bf16_f32 v184, v112, v113
  v_cvt_pk_bf16_f32 v185, v114, v115
  v_cvt_pk_bf16_f32 v186, v116, v117
  v_cvt_pk_bf16_f32 v187, v118, v119
  v_cvt_pk_bf16_f32 v188, v120, v121
  v_cvt_pk_bf16_f32 v189, v122, v123
  v_cvt_pk_bf16_f32 v190, v124, v125
  v_cvt_pk_bf16_f32 v191, v126, v127
  v_cvt_pk_bf16_f32 v192, v148, v149
  v_cvt_pk_bf16_f32 v193, v150, v151
  v_mov_b32 v194, 0
  v_mov_b32 v195, 0
  v_mfma_f32_32x32x16_bf16 v[112:127], v[160:163], v[184:187], 0
  v_mfma_f32_32x32x16_bf16 v[112:127], v[168:171], v[188:191], v[112:127]
  v_mfma_f32_32x32x16_bf16 v[112:127], v[176:179], v[192:195], v[112:127]
  v_mfma_f32_32x32x16_bf16 v[48:63], v[164:167], v[184:187], 0
  v_mfma_f32_32x32x16_bf16 v[48:63], v[172:175], v[188:191], v[48:63]
  v_mfma_f32_32x32x16_bf16 v[48:63], v[180:183], v[192:195], v[48:63]
  v_mul_f32 v128, v128, v25
  v_mul_f32 v129, v129, v25
  v_mul_f32 v130, v130, v25
  v_mul_f32 v131, v131, v25
  v_mul_f32 v132, v132, v25
  v_mul_f32 v133, v133, v25
  v_mul_f32 v134, v134, v25
  v_mul_f32 v135, v135, v25
  v_mul_f32 v136, v136, v25
  v_mul_f32 v137, v137, v25
  v_mul_f32 v138, v138, v25
  v_mul_f32 v139, v139, v25
  v_mul_f32 v140, v140, v25
  v_mul_f32 v141, v141, v25
  v_mul_f32 v142, v142, v25
  v_mul_f32 v143, v143, v25
  v_mul_f32 v152, v152, v25
  v_mul_f32 v153, v153, v25
  v_mul_f32 v154, v154, v25
  v_mul_f32 v155, v155, v25
  v_cvt_pk_bf16_f32 v196, v128, v129
  v_cvt_pk_bf16_f32 v197, v130, v131
  v_cvt_pk_bf16_f32 v198, v132, v133
  v_cvt_pk_bf16_f32 v199, v134, v135
  v_cvt_pk_bf16_f32 v200, v136, v137
  v_cvt_pk_bf16_f32 v201, v138, v139
  v_cvt_pk_bf16_f32 v202, v140, v141
  v_cvt_pk_bf16_f32 v203, v142, v143
  v_cvt_pk_bf16_f32 v204, v152, v153
  v_cvt_pk_bf16_f32 v205, v154, v155
  v_cmp_gt_u32 vcc, 32, v1
  v_mov_b32 v84, 0x3f80
  s_nop 0
  v_cndmask_b32 v196, v84, v196, vcc
  v_cndmask_b32 v205, v205, v84, vcc
  ds_write_b128 v91, v[196:199]
  ds_write_b128 v91, v[200:203] offset:16
  ds_write_b64 v91, v[204:205] offset:32
  v_mul_f32 v47, 0x3fb8aa3b, v25
  v_max3_f32 v28, v112, v113, v114
  v_min3_f32 v29, v112, v113, v114
  v_max3_f32 v28, v28, v115, v116
  v_min3_f32 v29, v29, v115, v116
  v_max3_f32 v28, v28, v117, v118
  v_min3_f32 v29, v29, v117, v118
  v_max3_f32 v28, v28, v119, v120
  v_min3_f32 v29, v29, v119, v120
  v_max3_f32 v28, v28, v121, v122
  v_min3_f32 v29, v29, v121, v122
  v_max3_f32 v28, v28, v123, v124
  v_min3_f32 v29, v29, v123, v124
  v_max3_f32 v28, v28, v125, v126
  v_min3_f32 v29, v29, v125, v126
  v_max3_f32 v28, v28, v127, v48
  v_min3_f32 v29, v29, v127, v48
  v_max_f32 v28, v28, v49
  v_min_f32 v29, v29, v49
  v_mul_f32 v30, v28, v47
  v_mul_f32 v32, v29, v47
  v_pk_fma_f32 v[218:219], v[112:113], v[46:47], v[30:31] op_sel:[0,1,0] op_sel_hi:[1,1,0] neg_lo:[0,0,1] neg_hi:[0,0,1]
  v_pk_fma_f32 v[236:237], v[112:113], v[46:47], v[32:33] op_sel:[0,1,0] op_sel_hi:[1,1,0] neg_lo:[0,1,0] neg_hi:[0,1,0]
  v_pk_fma_f32 v[220:221], v[114:115], v[46:47], v[30:31] op_sel:[0,1,0] op_sel_hi:[1,1,0] neg_lo:[0,0,1] neg_hi:[0,0,1]
  v_pk_fma_f32 v[238:239], v[114:115], v[46:47], v[32:33] op_sel:[0,1,0] op_sel_hi:[1,1,0] neg_lo:[0,1,0] neg_hi:[0,1,0]
  v_pk_fma_f32 v[222:223], v[116:117], v[46:47], v[30:31] op_sel:[0,1,0] op_sel_hi:[1,1,0] neg_lo:[0,0,1] neg_hi:[0,0,1]
  v_pk_fma_f32 v[240:241], v[116:117], v[46:47], v[32:33] op_sel:[0,1,0] op_sel_hi:[1,1,0] neg_lo:[0,1,0] neg_hi:[0,1,0]
  v_pk_fma_f32 v[224:225], v[118:119], v[46:47], v[30:31] op_sel:[0,1,0] op_sel_hi:[1,1,0] neg_lo:[0,0,1] neg_hi:[0,0,1]
  v_pk_fma_f32 v[242:243], v[118:119], v[46:47], v[32:33] op_sel:[0,1,0] op_sel_hi:[1,1,0] neg_lo:[0,1,0] neg_hi:[0,1,0]
  v_pk_fma_f32 v[226:227], v[120:121], v[46:47], v[30:31] op_sel:[0,1,0] op_sel_hi:[1,1,0] neg_lo:[0,0,1] neg_hi:[0,0,1]
  v_pk_fma_f32 v[244:245], v[120:121], v[46:47], v[32:33] op_sel:[0,1,0] op_sel_hi:[1,1,0] neg_lo:[0,1,0] neg_hi:[0,1,0]
  v_pk_fma_f32 v[228:229], v[122:123], v[46:47], v[30:31] op_sel:[0,1,0] op_sel_hi:[1,1,0] neg_lo:[0,0,1] neg_hi:[0,0,1]
  v_pk_fma_f32 v[246:247], v[122:123], v[46:47], v[32:33] op_sel:[0,1,0] op_sel_hi:[1,1,0] neg_lo:[0,1,0] neg_hi:[0,1,0]
  v_pk_fma_f32 v[230:231], v[124:125], v[46:47], v[30:31] op_sel:[0,1,0] op_sel_hi:[1,1,0] neg_lo:[0,0,1] neg_hi:[0,0,1]
  v_pk_fma_f32 v[248:249], v[124:125], v[46:47], v[32:33] op_sel:[0,1,0] op_sel_hi:[1,1,0] neg_lo:[0,1,0] neg_hi:[0,1,0]
  v_pk_fma_f32 v[232:233], v[126:127], v[46:47], v[30:31] op_sel:[0,1,0] op_sel_hi:[1,1,0] neg_lo:[0,0,1] neg_hi:[0,0,1]
  v_pk_fma_f32 v[250:251], v[126:127], v[46:47], v[32:33] op_sel:[0,1,0] op_sel_hi:[1,1,0] neg_lo:[0,1,0] neg_hi:[0,1,0]
  v_pk_fma_f32 v[234:235], v[48:49], v[46:47], v[30:31] op_sel:[0,1,0] op_sel_hi:[1,1,0] neg_lo:[0,0,1] neg_hi:[0,0,1]
  v_pk_fma_f32 v[252:253], v[48:49], v[46:47], v[32:33] op_sel:[0,1,0] op_sel_hi:[1,1,0] neg_lo:[0,1,0] neg_hi:[0,1,0]
  v_exp_f32 v218, v218
  v_exp_f32 v236, v236
  v_exp_f32 v219, v219
  v_exp_f32 v237, v237
  v_exp_f32 v220, v220
  v_exp_f32 v238, v238
  v_exp_f32 v221, v221
  v_exp_f32 v239, v239
  v_exp_f32 v222, v222
  v_exp_f32 v240, v240
  v_exp_f32 v223, v223
  v_exp_f32 v241, v241
  v_exp_f32 v224, v224
  v_exp_f32 v242, v242
  v_exp_f32 v225, v225
  v_exp_f32 v243, v243
  v_exp_f32 v226, v226
  v_exp_f32 v244, v244
  v_exp_f32 v227, v227
  v_exp_f32 v245, v245
  v_exp_f32 v228, v228
  v_exp_f32 v246, v246
  v_exp_f32 v229, v229
  v_exp_f32 v247, v247
  v_exp_f32 v230, v230
  v_exp_f32 v248, v248
  v_exp_f32 v231, v231
  v_exp_f32 v249, v249
  v_exp_f32 v232, v232
  v_exp_f32 v250, v250
  v_exp_f32 v233, v233
  v_exp_f32 v251, v251
  v_exp_f32 v234, v234
  v_exp_f32 v252, v252
  v_exp_f32 v235, v235
  v_exp_f32 v253, v253
  v_pk_add_f32 v[34:35], v[218:219], v[220:221]
  v_pk_add_f32 v[36:37], v[236:237], v[238:239]
  v_pk_add_f32 v[34:35], v[34:35], v[222:223]
  v_pk_add_f32 v[36:37], v[36:37], v[240:241]
  v_pk_add_f32 v[34:35], v[34:35], v[224:225]
  v_pk_add_f32 v[36:37], v[36:37], v[242:243]
  v_pk_add_f32 v[34:35], v[34:35], v[226:227]
  v_pk_add_f32 v[36:37], v[36:37], v[244:245]
  v_pk_add_f32 v[34:35], v[34:35], v[228:229]
  v_pk_add_f32 v[36:37], v[36:37], v[246:247]
  v_pk_add_f32 v[34:35], v[34:35], v[230:231]
  v_pk_add_f32 v[36:37], v[36:37], v[248:249]
  v_pk_add_f32 v[34:35], v[34:35], v[232:233]
  v_pk_add_f32 v[36:37], v[36:37], v[250:251]
  v_pk_add_f32 v[34:35], v[34:35], v[234:235]
  v_pk_add_f32 v[36:37], v[36:37], v[252:253]
  v_add_f32 v34, v34, v35
  v_add_f32 v36, v36, v37
  v_rcp_f32 v34, v34
  v_rcp_f32 v36, v36
  v_pk_mul_f32 v[218:219], v[218:219], v[34:35] op_sel_hi:[1,0]
  v_pk_mul_f32 v[236:237], v[236:237], v[36:37] op_sel_hi:[1,0]
  v_pk_mul_f32 v[220:221], v[220:221], v[34:35] op_sel_hi:[1,0]
  v_pk_mul_f32 v[238:239], v[238:239], v[36:37] op_sel_hi:[1,0]
  v_pk_mul_f32 v[222:223], v[222:223], v[34:35] op_sel_hi:[1,0]
  v_pk_mul_f32 v[240:241], v[240:241], v[36:37] op_sel_hi:[1,0]
  v_pk_mul_f32 v[224:225], v[224:225], v[34:35] op_sel_hi:[1,0]
  v_pk_mul_f32 v[242:243], v[242:243], v[36:37] op_sel_hi:[1,0]
  v_pk_mul_f32 v[226:227], v[226:227], v[34:35] op_sel_hi:[1,0]
  v_pk_mul_f32 v[244:245], v[244:245], v[36:37] op_sel_hi:[1,0]
  v_pk_mul_f32 v[228:229], v[228:229], v[34:35] op_sel_hi:[1,0]
  v_pk_mul_f32 v[246:247], v[246:247], v[36:37] op_sel_hi:[1,0]
  v_pk_mul_f32 v[230:231], v[230:231], v[34:35] op_sel_hi:[1,0]
  v_pk_mul_f32 v[248:249], v[248:249], v[36:37] op_sel_hi:[1,0]
  v_pk_mul_f32 v[232:233], v[232:233], v[34:35] op_sel_hi:[1,0]
  v_pk_mul_f32 v[250:251], v[250:251], v[36:37] op_sel_hi:[1,0]
  v_pk_mul_f32 v[234:235], v[234:235], v[34:35] op_sel_hi:[1,0]
  v_pk_mul_f32 v[252:253], v[252:253], v[36:37] op_sel_hi:[1,0]
  v_cvt_pk_bf16_f32 v48, v218, v219
  v_cvt_pk_bf16_f32 v49, v220, v221
  v_cvt_pk_bf16_f32 v50, v222, v223
  v_cvt_pk_bf16_f32 v51, v224, v225
  v_cvt_pk_bf16_f32 v52, v226, v227
  v_cvt_pk_bf16_f32 v53, v228, v229
  v_cvt_pk_bf16_f32 v54, v230, v231
  v_cvt_pk_bf16_f32 v55, v232, v233
  v_cvt_pk_bf16_f32 v56, v234, v235
  v_cvt_pk_bf16_f32 v57, v236, v237
  v_cvt_pk_bf16_f32 v58, v238, v239
  v_cvt_pk_bf16_f32 v59, v240, v241
  v_cvt_pk_bf16_f32 v60, v242, v243
  v_cvt_pk_bf16_f32 v61, v244, v245
  v_cvt_pk_bf16_f32 v62, v246, v247
  v_cvt_pk_bf16_f32 v63, v248, v249
  v_cvt_pk_bf16_f32 v64, v250, v251
  v_cvt_pk_bf16_f32 v65, v252, v253
  ds_write_b128 v91, v[48:51] offset:48
  ds_write_b128 v91, v[52:55] offset:64
  ds_write_b128 v91, v[56:59] offset:80
  ds_write_b128 v91, v[60:63] offset:96
  ds_write_b64 v91, v[64:65] offset:112
  s_waitcnt lgkmcnt(0)
  v_mov_b32 v84, 158236
  s_mov_b64 exec, 1
  s_mov_b32 s59, 0
  v_mov_b32 v85, 1
  ds_add_rtn_u32 v85, v84, v85
  s_waitcnt lgkmcnt(0)
  v_readfirstlane_b32 s63, v85
  s_nop 0
  s_cmp_ge_u32 s63, 3
  s_cbranch_scc1 Llsd_48
Lls_47:
  ds_read_b32 v85, v84
  s_add_u32 s59, s59, 1
  s_cmp_ge_u32 s59, 4000000
  s_waitcnt lgkmcnt(0)
  v_readfirstlane_b32 s63, v85
  s_cbranch_scc1 Llsd_48
  s_cmp_lt_u32 s63, 4
  s_cbranch_scc1 Lls_47
Llsd_48:
  s_mov_b64 exec, -1
  ds_read_b64_tr_b16 v[238:239], v93 offset:0
  ds_read_b64_tr_b16 v[240:241], v93 offset:2560
  ds_read_b64_tr_b16 v[28:29], v92 offset:0
  ds_read_b64_tr_b16 v[30:31], v92 offset:2560
  ds_read_b64_tr_b16 v[32:33], v92 offset:32
  ds_read_b64_tr_b16 v[34:35], v92 offset:2592
  ds_read_b64_tr_b16 v[36:37], v92 offset:64
  ds_read_b64_tr_b16 v[38:39], v92 offset:2624
  ds_read_b64_tr_b16 v[242:243], v93 offset:5120
  ds_read_b64_tr_b16 v[244:245], v93 offset:7680
  ds_read_b64_tr_b16 v[40:41], v92 offset:5120
  ds_read_b64_tr_b16 v[42:43], v92 offset:7680
  ds_read_b64_tr_b16 v[44:45], v92 offset:5152
  ds_read_b64_tr_b16 v[46:47], v92 offset:7712
  ds_read_b64_tr_b16 v[48:49], v92 offset:5184
  ds_read_b64_tr_b16 v[50:51], v92 offset:7744
  ds_read_b64_tr_b16 v[246:247], v93 offset:10240
  ds_read_b64_tr_b16 v[248:249], v93 offset:12800
  ds_read_b64_tr_b16 v[112:113], v92 offset:10240
  ds_read_b64_tr_b16 v[114:115], v92 offset:12800
  ds_read_b64_tr_b16 v[116:117], v92 offset:10272
  ds_read_b64_tr_b16 v[118:119], v92 offset:12832
  ds_read_b64_tr_b16 v[120:121], v92 offset:10304
  ds_read_b64_tr_b16 v[122:123], v92 offset:12864
  ds_read_b64_tr_b16 v[250:251], v93 offset:15360
  ds_read_b64_tr_b16 v[252:253], v93 offset:17920
  ds_read_b64_tr_b16 v[124:125], v92 offset:15360
  ds_read_b64_tr_b16 v[126:127], v92 offset:17920
  ds_read_b64_tr_b16 v[128:129], v92 offset:15392
  ds_read_b64_tr_b16 v[130:131], v92 offset:17952
  ds_read_b64_tr_b16 v[132:133], v92 offset:15424
  ds_read_b64_tr_b16 v[134:135], v92 offset:17984
  s_waitcnt lgkmcnt(15)
  v_mfma_f32_16x16x32_bf16 v[218:221], v[28:31], v[238:241], 0
  v_mfma_f32_16x16x32_bf16 v[222:225], v[32:35], v[238:241], 0
  v_mfma_f32_16x16x32_bf16 v[226:229], v[36:39], v[238:241], 0
  v_mfma_f32_16x16x32_bf16 v[218:221], v[40:43], v[242:245], v[218:221]
  v_mfma_f32_16x16x32_bf16 v[222:225], v[44:47], v[242:245], v[222:225]
  v_mfma_f32_16x16x32_bf16 v[226:229], v[48:51], v[242:245], v[226:229]
  s_waitcnt lgkmcnt(8)
  v_mfma_f32_16x16x32_bf16 v[218:221], v[112:115], v[246:249], v[218:221]
  v_mfma_f32_16x16x32_bf16 v[222:225], v[116:119], v[246:249], v[222:225]
  v_mfma_f32_16x16x32_bf16 v[226:229], v[120:123], v[246:249], v[226:229]
  s_waitcnt lgkmcnt(0)
  v_mfma_f32_16x16x32_bf16 v[218:221], v[124:127], v[250:253], v[218:221]
  v_mfma_f32_16x16x32_bf16 v[222:225], v[128:131], v[250:253], v[222:225]
  v_mfma_f32_16x16x32_bf16 v[226:229], v[132:135], v[250:253], v[226:229]
  s_nop 5
  v_cvt_pk_bf16_f32 v232, v218, v219
  v_cvt_pk_bf16_f32 v233, v220, v221
  v_cvt_pk_bf16_f32 v234, v222, v223
  v_cvt_pk_bf16_f32 v235, v224, v225
  v_cvt_pk_bf16_f32 v236, v226, v227
  v_cvt_pk_bf16_f32 v237, v228, v229
  buffer_store_dwordx4 v[232:235], v94, s[36:39], s3 offen sc1
  buffer_store_dwordx2 v[236:237], v95, s[36:39], s3 offen sc1
  v_cvt_pk_bf16_f32 v184, v96, v97
  v_cvt_pk_bf16_f32 v185, v98, v99
  v_cvt_pk_bf16_f32 v186, v100, v101
  v_cvt_pk_bf16_f32 v187, v102, v103
  v_cvt_pk_bf16_f32 v188, v104, v105
  v_cvt_pk_bf16_f32 v189, v106, v107
  v_cvt_pk_bf16_f32 v190, v108, v109
  v_cvt_pk_bf16_f32 v191, v110, v111
  v_cvt_pk_bf16_f32 v192, v144, v145
  v_cvt_pk_bf16_f32 v193, v146, v147
  v_mov_b32 v194, 0
  v_mov_b32 v195, 0
  v_mfma_f32_32x32x16_bf16 v[112:127], v[160:163], v[184:187], 0
  v_mfma_f32_32x32x16_bf16 v[112:127], v[168:171], v[188:191], v[112:127]
  v_mfma_f32_32x32x16_bf16 v[112:127], v[176:179], v[192:195], v[112:127]
  v_mfma_f32_32x32x16_bf16 v[48:63], v[164:167], v[184:187], 0
  v_mfma_f32_32x32x16_bf16 v[48:63], v[172:175], v[188:191], v[48:63]
  v_mfma_f32_32x32x16_bf16 v[48:63], v[180:183], v[192:195], v[48:63]
  s_lshl_b32 s62, s50, 7
  s_lshl_b32 s63, s49, 2
  s_add_u32 s62, s62, s63
  s_add_u32 s62, s62, 45056
  s_waitcnt vmcnt(0)
  v_mov_b32 v84, 158208
  v_mov_b32 v85, 1
  s_mov_b64 exec, 1
  ds_add_rtn_u32 v85, v84, v85
  s_waitcnt lgkmcnt(0)
  v_readfirstlane_b32 s63, v85
  s_nop 0
  s_cmp_eq_u32 s63, 3
  s_cselect_b32 s62, s62, 0x7fff0000
  v_mov_b32 v84, s62
  v_mov_b32 v85, s51
  buffer_store_dword v85, v84, s[36:39], 0 offen sc1
  s_mov_b64 exec, -1
  v_mul_f32 v47, 0x3fb8aa3b, v25
  v_max3_f32 v28, v112, v113, v114
  v_min3_f32 v29, v112, v113, v114
  v_max3_f32 v28, v28, v115, v116
  v_min3_f32 v29, v29, v115, v116
  v_max3_f32 v28, v28, v117, v118
  v_min3_f32 v29, v29, v117, v118
  v_max3_f32 v28, v28, v119, v120
  v_min3_f32 v29, v29, v119, v120
  v_max3_f32 v28, v28, v121, v122
  v_min3_f32 v29, v29, v121, v122
  v_max3_f32 v28, v28, v123, v124
  v_min3_f32 v29, v29, v123, v124
  v_max3_f32 v28, v28, v125, v126
  v_min3_f32 v29, v29, v125, v126
  v_max3_f32 v28, v28, v127, v48
  v_min3_f32 v29, v29, v127, v48
  v_max_f32 v28, v28, v49
  v_min_f32 v29, v29, v49
  v_mul_f32 v30, v28, v47
  v_mul_f32 v32, v29, v47
  v_pk_fma_f32 v[218:219], v[112:113], v[46:47], v[30:31] op_sel:[0,1,0] op_sel_hi:[1,1,0] neg_lo:[0,0,1] neg_hi:[0,0,1]
  v_pk_fma_f32 v[236:237], v[112:113], v[46:47], v[32:33] op_sel:[0,1,0] op_sel_hi:[1,1,0] neg_lo:[0,1,0] neg_hi:[0,1,0]
  v_pk_fma_f32 v[220:221], v[114:115], v[46:47], v[30:31] op_sel:[0,1,0] op_sel_hi:[1,1,0] neg_lo:[0,0,1] neg_hi:[0,0,1]
  v_pk_fma_f32 v[238:239], v[114:115], v[46:47], v[32:33] op_sel:[0,1,0] op_sel_hi:[1,1,0] neg_lo:[0,1,0] neg_hi:[0,1,0]
  v_pk_fma_f32 v[222:223], v[116:117], v[46:47], v[30:31] op_sel:[0,1,0] op_sel_hi:[1,1,0] neg_lo:[0,0,1] neg_hi:[0,0,1]
  v_pk_fma_f32 v[240:241], v[116:117], v[46:47], v[32:33] op_sel:[0,1,0] op_sel_hi:[1,1,0] neg_lo:[0,1,0] neg_hi:[0,1,0]
  v_pk_fma_f32 v[224:225], v[118:119], v[46:47], v[30:31] op_sel:[0,1,0] op_sel_hi:[1,1,0] neg_lo:[0,0,1] neg_hi:[0,0,1]
  v_pk_fma_f32 v[242:243], v[118:119], v[46:47], v[32:33] op_sel:[0,1,0] op_sel_hi:[1,1,0] neg_lo:[0,1,0] neg_hi:[0,1,0]
  v_pk_fma_f32 v[226:227], v[120:121], v[46:47], v[30:31] op_sel:[0,1,0] op_sel_hi:[1,1,0] neg_lo:[0,0,1] neg_hi:[0,0,1]
  v_pk_fma_f32 v[244:245], v[120:121], v[46:47], v[32:33] op_sel:[0,1,0] op_sel_hi:[1,1,0] neg_lo:[0,1,0] neg_hi:[0,1,0]
  v_pk_fma_f32 v[228:229], v[122:123], v[46:47], v[30:31] op_sel:[0,1,0] op_sel_hi:[1,1,0] neg_lo:[0,0,1] neg_hi:[0,0,1]
  v_pk_fma_f32 v[246:247], v[122:123], v[46:47], v[32:33] op_sel:[0,1,0] op_sel_hi:[1,1,0] neg_lo:[0,1,0] neg_hi:[0,1,0]
  v_pk_fma_f32 v[230:231], v[124:125], v[46:47], v[30:31] op_sel:[0,1,0] op_sel_hi:[1,1,0] neg_lo:[0,0,1] neg_hi:[0,0,1]
  v_pk_fma_f32 v[248:249], v[124:125], v[46:47], v[32:33] op_sel:[0,1,0] op_sel_hi:[1,1,0] neg_lo:[0,1,0] neg_hi:[0,1,0]
  v_pk_fma_f32 v[232:233], v[126:127], v[46:47], v[30:31] op_sel:[0,1,0] op_sel_hi:[1,1,0] neg_lo:[0,0,1] neg_hi:[0,0,1]
  v_pk_fma_f32 v[250:251], v[126:127], v[46:47], v[32:33] op_sel:[0,1,0] op_sel_hi:[1,1,0] neg_lo:[0,1,0] neg_hi:[0,1,0]
  v_pk_fma_f32 v[234:235], v[48:49], v[46:47], v[30:31] op_sel:[0,1,0] op_sel_hi:[1,1,0] neg_lo:[0,0,1] neg_hi:[0,0,1]
  v_pk_fma_f32 v[252:253], v[48:49], v[46:47], v[32:33] op_sel:[0,1,0] op_sel_hi:[1,1,0] neg_lo:[0,1,0] neg_hi:[0,1,0]
  v_exp_f32 v218, v218
  v_exp_f32 v236, v236
  v_exp_f32 v219, v219
  v_exp_f32 v237, v237
  v_exp_f32 v220, v220
  v_exp_f32 v238, v238
  v_exp_f32 v221, v221
  v_exp_f32 v239, v239
  v_exp_f32 v222, v222
  v_exp_f32 v240, v240
  v_exp_f32 v223, v223
  v_exp_f32 v241, v241
  v_exp_f32 v224, v224
  v_exp_f32 v242, v242
  v_exp_f32 v225, v225
  v_exp_f32 v243, v243
  v_exp_f32 v226, v226
  v_exp_f32 v244, v244
  v_exp_f32 v227, v227
  v_exp_f32 v245, v245
  v_exp_f32 v228, v228
  v_exp_f32 v246, v246
  v_exp_f32 v229, v229
  v_exp_f32 v247, v247
  v_exp_f32 v230, v230
  v_exp_f32 v248, v248
  v_exp_f32 v231, v231
  v_exp_f32 v249, v249
  v_exp_f32 v232, v232
  v_exp_f32 v250, v250
  v_exp_f32 v233, v233
  v_exp_f32 v251, v251
  v_exp_f32 v234, v234
  v_exp_f32 v252, v252
  v_exp_f32 v235, v235
  v_exp_f32 v253, v253
  v_pk_add_f32 v[34:35], v[218:219], v[220:221]
  v_pk_add_f32 v[36:37], v[236:237], v[238:239]
  v_pk_add_f32 v[34:35], v[34:35], v[222:223]
  v_pk_add_f32 v[36:37], v[36:37], v[240:241]
  v_pk_add_f32 v[34:35], v[34:35], v[224:225]
  v_pk_add_f32 v[36:37], v[36:37], v[242:243]
  v_pk_add_f32 v[34:35], v[34:35], v[226:227]
  v_pk_add_f32 v[36:37], v[36:37], v[244:245]
  v_pk_add_f32 v[34:35], v[34:35], v[228:229]
  v_pk_add_f32 v[36:37], v[36:37], v[246:247]
  v_pk_add_f32 v[34:35], v[34:35], v[230:231]
  v_pk_add_f32 v[36:37], v[36:37], v[248:249]
  v_pk_add_f32 v[34:35], v[34:35], v[232:233]
  v_pk_add_f32 v[36:37], v[36:37], v[250:251]
  v_pk_add_f32 v[34:35], v[34:35], v[234:235]
  v_pk_add_f32 v[36:37], v[36:37], v[252:253]
  v_add_f32 v34, v34, v35
  v_add_f32 v36, v36, v37
  v_rcp_f32 v34, v34
  v_rcp_f32 v36, v36
  v_pk_mul_f32 v[218:219], v[218:219], v[34:35] op_sel_hi:[1,0]
  v_pk_mul_f32 v[236:237], v[236:237], v[36:37] op_sel_hi:[1,0]
  v_pk_mul_f32 v[220:221], v[220:221], v[34:35] op_sel_hi:[1,0]
  v_pk_mul_f32 v[238:239], v[238:239], v[36:37] op_sel_hi:[1,0]
  v_pk_mul_f32 v[222:223], v[222:223], v[34:35] op_sel_hi:[1,0]
  v_pk_mul_f32 v[240:241], v[240:241], v[36:37] op_sel_hi:[1,0]
  v_pk_mul_f32 v[224:225], v[224:225], v[34:35] op_sel_hi:[1,0]
  v_pk_mul_f32 v[242:243], v[242:243], v[36:37] op_sel_hi:[1,0]
  v_pk_mul_f32 v[226:227], v[226:227], v[34:35] op_sel_hi:[1,0]
  v_pk_mul_f32 v[244:245], v[244:245], v[36:37] op_sel_hi:[1,0]
  v_pk_mul_f32 v[228:229], v[228:229], v[34:35] op_sel_hi:[1,0]
  v_pk_mul_f32 v[246:247], v[246:247], v[36:37] op_sel_hi:[1,0]
  v_pk_mul_f32 v[230:231], v[230:231], v[34:35] op_sel_hi:[1,0]
  v_pk_mul_f32 v[248:249], v[248:249], v[36:37] op_sel_hi:[1,0]
  v_pk_mul_f32 v[232:233], v[232:233], v[34:35] op_sel_hi:[1,0]
  v_pk_mul_f32 v[250:251], v[250:251], v[36:37] op_sel_hi:[1,0]
  v_pk_mul_f32 v[234:235], v[234:235], v[34:35] op_sel_hi:[1,0]
  v_pk_mul_f32 v[252:253], v[252:253], v[36:37] op_sel_hi:[1,0]
  v_cvt_pk_bf16_f32 v196, v218, v219
  v_cvt_pk_bf16_f32 v197, v220, v221
  v_cvt_pk_bf16_f32 v198, v222, v223
  v_cvt_pk_bf16_f32 v199, v224, v225
  v_cvt_pk_bf16_f32 v200, v226, v227
  v_cvt_pk_bf16_f32 v201, v228, v229
  v_cvt_pk_bf16_f32 v202, v230, v231
  v_cvt_pk_bf16_f32 v203, v232, v233
  v_cvt_pk_bf16_f32 v204, v234, v235
  v_cvt_pk_bf16_f32 v205, v236, v237
  v_cvt_pk_bf16_f32 v206, v238, v239
  v_cvt_pk_bf16_f32 v207, v240, v241
  v_cvt_pk_bf16_f32 v208, v242, v243
  v_cvt_pk_bf16_f32 v209, v244, v245
  v_cvt_pk_bf16_f32 v210, v246, v247
  v_cvt_pk_bf16_f32 v211, v248, v249
  v_cvt_pk_bf16_f32 v212, v250, v251
  v_cvt_pk_bf16_f32 v213, v252, v253
  v_mov_b32 v214, 0
  v_mov_b32 v215, 0
  v_bfe_u32 v84, v1, 2, 1
  v_lshrrev_b32 v85, 5, v1
  v_cmp_eq_u32 vcc, v84, v85
  v_bfe_u32 v86, v1, 3, 2
  v_and_b32 v87, 3, v1
  v_lshl_add_u32 v86, v86, 2, v87
  v_mul_u32_u24 v86, 80, v86
  v_mul_u32_u24 v85, 1600, v85
  v_add_u32 v86, v86, v85
  v_add_u32 v86, 137728, v86
  v_mov_b32 v87, 134144
  v_cndmask_b32 v2, v87, v86, vcc
  s_and_b32 s57, s50, 1
  s_mul_i32 s62, s48, 2560
  s_add_u32 s62, s62, 141824
  v_and_b32 v84, 31, v1
  v_mul_u32_u24 v84, 80, v84
  v_add_u32 v84, s62, v84
  v_lshrrev_b32 v85, 5, v1
  v_mul_u32_u24 v85, 36, v85
  s_lshl_b32 s63, s57, 3
  v_add3_u32 v3, v84, v85, s63
  s_cmp_eq_u32 s57, 0
  s_cselect_b32 s63, 64, 8
  v_add_u32 v5, s63, v84
  v_and_b32 v84, 15, v1
  v_lshrrev_b32 v86, 4, v1
  v_add_u32 v86, s57, v86
  v_mul_u32_u24 v87, 80, v84
  v_lshl_add_u32 v87, v86, 4, v87
  v_add_u32 v4, s62, v87
  s_mul_i32 s62, s50, 9
  s_sub_u32 s62, s62, s57
  s_lshr_b32 s62, s62, 1
  v_add_u32 v86, s62, v86
  v_lshrrev_b32 v89, 2, v86
  v_and_b32 v86, 3, v86
  v_lshlrev_b32 v89, 10, v89
  v_lshl_add_u32 v89, v86, 8, v89
  v_lshl_add_u32 v6, v84, 4, v89
  s_cmp_eq_u32 s57, 0
  s_cselect_b32 s63, 4, 0
  s_add_u32 s63, s63, s62
  s_lshr_b32 s47, s63, 2
  s_lshl_b32 s47, s47, 10
  s_and_b32 s63, s63, 3
  s_lshl_b32 s63, s63, 8
  s_add_u32 s47, s47, s63
  s_lshl_b32 s63, s57, 3
  s_add_u32 s47, s47, s63
  v_lshlrev_b32 v84, 4, v84
  v_bfe_u32 v90, v1, 4, 1
  v_mul_u32_u24 v90, 18432, v90
  v_add3_u32 v90, v90, v84, s47
  v_cmp_gt_u32 vcc, 32, v1
  v_mov_b32 v84, 0x7fff0000
  s_nop 0
  v_cndmask_b32 v7, v84, v90, vcc
  s_lshl_b32 s62, s49, 3
  s_lshl_b32 s63, s48, 1
  s_add_u32 s62, s62, s63
  s_mul_i32 s62, s62, 18432
  s_add_u32 s46, s62, 1540096
  s_add_u32 s47, s46, 18432
  s_lshl_b32 s62, s44, 6
  s_lshl_b32 s63, s48, 4
  s_add_u32 s62, s62, s63
  s_mul_i32 s63, s45, 144
  v_add_u32 v84, 0, v1
  v_mul_u32_u24 v85, 7282, v84
  v_lshrrev_b32 v85, 16, v85
  v_mul_u32_u24 v86, 9, v85
  v_sub_u32 v86, v84, v86
  v_mul_u32_u24 v87, 304, v85
  v_lshl_add_u32 v184, v86, 5, v87
  v_add_u32 v85, s62, v85
  v_mul_u32_u24 v87, 1152, v85
  v_lshl_add_u32 v87, v86, 4, v87
  v_add_u32 v187, s63, v87
  v_lshlrev_b32 v85, 4, v85
  v_add_u32 v8, 4096, v85
  v_add_u32 v84, 64, v1
  v_mul_u32_u24 v85, 7282, v84
  v_lshrrev_b32 v85, 16, v85
  v_mul_u32_u24 v86, 9, v85
  v_sub_u32 v86, v84, v86
  v_mul_u32_u24 v87, 304, v85
  v_lshl_add_u32 v185, v86, 5, v87
  v_add_u32 v85, s62, v85
  v_mul_u32_u24 v87, 1152, v85
  v_lshl_add_u32 v87, v86, 4, v87
  v_add_u32 v188, s63, v87
  v_lshlrev_b32 v85, 4, v85
  v_add_u32 v9, 4096, v85
  v_add_u32 v84, 128, v1
  v_mul_u32_u24 v85, 7282, v84
  v_lshrrev_b32 v85, 16, v85
  v_mul_u32_u24 v86, 9, v85
  v_sub_u32 v86, v84, v86
  v_mul_u32_u24 v87, 304, v85
  v_lshl_add_u32 v186, v86, 5, v87
  v_add_u32 v85, s62, v85
  v_mul_u32_u24 v87, 1152, v85
  v_lshl_add_u32 v87, v86, 4, v87
  v_add_u32 v189, s63, v87
  v_cmp_gt_u32 vcc, 16, v1
  v_mov_b32 v88, 0x7fff0000
  s_nop 0
  v_cndmask_b32 v189, v88, v189, vcc
  v_lshlrev_b32 v85, 4, v85
  v_add_u32 v10, 4096, v85
  v_mov_b32 v84, 158224
  s_mov_b64 exec, 1
  s_mov_b32 s59, 0
Lls_50:
  ds_read_b32 v85, v84
  s_add_u32 s59, s59, 1
  s_cmp_ge_u32 s59, 4000000
  s_waitcnt lgkmcnt(0)
  v_readfirstlane_b32 s63, v85
  s_cbranch_scc1 Llsd_51
  s_cmp_lt_u32 s63, 2
  s_cbranch_scc1 Lls_50
Llsd_51:
  s_mov_b64 exec, -1
  ds_read_b128 v[28:31], v2 offset:0
  ds_read_b128 v[32:35], v2 offset:16
  ds_read_b128 v[36:39], v2 offset:32
  ds_read_b128 v[40:43], v2 offset:48
  ds_read_b128 v[44:47], v2 offset:64
  ds_read_b128 v[48:51], v2 offset:1280
  ds_read_b128 v[52:55], v2 offset:1296
  ds_read_b128 v[56:59], v2 offset:1312
  ds_read_b128 v[60:63], v2 offset:1328
  ds_read_b128 v[64:67], v2 offset:1344
  s_waitcnt lgkmcnt(9)
  v_mfma_f32_32x32x16_bf16 v[96:111], v[28:31], v[196:199], 0
  s_waitcnt lgkmcnt(4)
  v_mfma_f32_32x32x16_bf16 v[112:127], v[48:51], v[196:199], 0
  v_mfma_f32_32x32x16_bf16 v[96:111], v[32:35], v[200:203], v[96:111]
  s_waitcnt lgkmcnt(3)
  v_mfma_f32_32x32x16_bf16 v[112:127], v[52:55], v[200:203], v[112:127]
  v_mfma_f32_32x32x16_bf16 v[96:111], v[36:39], v[204:207], v[96:111]
  s_waitcnt lgkmcnt(2)
  v_mfma_f32_32x32x16_bf16 v[112:127], v[56:59], v[204:207], v[112:127]
  v_mfma_f32_32x32x16_bf16 v[96:111], v[40:43], v[208:211], v[96:111]
  s_waitcnt lgkmcnt(1)
  v_mfma_f32_32x32x16_bf16 v[112:127], v[60:63], v[208:211], v[112:127]
  v_mfma_f32_32x32x16_bf16 v[96:111], v[44:47], v[212:215], v[96:111]
  s_waitcnt lgkmcnt(0)
  v_mfma_f32_32x32x16_bf16 v[112:127], v[64:67], v[212:215], v[112:127]
  v_cmp_gt_u32 vcc, 32, v1
  s_nop 10
  v_cndmask_b32 v87, v96, v114, vcc
  v_add_f32 v87, 0x358637bd, v87
  v_rcp_f32 v87, v87
  s_nop 0
  v_pk_mul_f32 v[96:97], v[96:97], v[86:87] op_sel:[0,1] op_sel_hi:[1,1]
  v_pk_mul_f32 v[98:99], v[98:99], v[86:87] op_sel:[0,1] op_sel_hi:[1,1]
  v_pk_mul_f32 v[100:101], v[100:101], v[86:87] op_sel:[0,1] op_sel_hi:[1,1]
  v_pk_mul_f32 v[102:103], v[102:103], v[86:87] op_sel:[0,1] op_sel_hi:[1,1]
  v_pk_mul_f32 v[104:105], v[104:105], v[86:87] op_sel:[0,1] op_sel_hi:[1,1]
  v_pk_mul_f32 v[106:107], v[106:107], v[86:87] op_sel:[0,1] op_sel_hi:[1,1]
  v_pk_mul_f32 v[108:109], v[108:109], v[86:87] op_sel:[0,1] op_sel_hi:[1,1]
  v_pk_mul_f32 v[110:111], v[110:111], v[86:87] op_sel:[0,1] op_sel_hi:[1,1]
  v_pk_mul_f32 v[112:113], v[112:113], v[86:87] op_sel:[0,1] op_sel_hi:[1,1]
  v_pk_mul_f32 v[114:115], v[114:115], v[86:87] op_sel:[0,1] op_sel_hi:[1,1]
  v_cvt_pk_bf16_f32 v28, v96, v97
  v_cvt_pk_bf16_f32 v29, v98, v99
  v_cvt_pk_bf16_f32 v30, v100, v101
  v_cvt_pk_bf16_f32 v31, v102, v103
  v_cvt_pk_bf16_f32 v32, v104, v105
  v_cvt_pk_bf16_f32 v33, v106, v107
  v_cvt_pk_bf16_f32 v34, v108, v109
  v_cvt_pk_bf16_f32 v35, v110, v111
  v_cvt_pk_bf16_f32 v36, v112, v113
  v_cvt_pk_bf16_f32 v37, v114, v115
  v_cndmask_b32 v28, v29, v28, vcc
  v_cndmask_b32 v29, v30, v29, vcc
  v_cndmask_b32 v30, v31, v30, vcc
  v_cndmask_b32 v31, v32, v31, vcc
  v_cndmask_b32 v32, v33, v32, vcc
  v_cndmask_b32 v33, v34, v33, vcc
  v_cndmask_b32 v34, v35, v34, vcc
  v_cndmask_b32 v35, v36, v35, vcc
  v_cndmask_b32 v36, v37, v36, vcc
  ds_write2_b32 v3, v28, v29 offset0:0 offset1:1
  ds_write2_b32 v3, v30, v31 offset0:2 offset1:3
  ds_write2_b32 v3, v32, v33 offset0:4 offset1:5
  ds_write2_b32 v3, v34, v35 offset0:6 offset1:7
  ds_write_b32 v3, v36 offset:32
  s_waitcnt lgkmcnt(0)
  ds_read_b128 v[40:43], v4
  ds_read_b128 v[44:47], v4 offset:1280
  ds_read_b64 v[48:49], v5
  s_waitcnt lgkmcnt(2)
  buffer_store_dwordx4 v[40:43], v6, s[36:39], s46 offen sc1
  s_waitcnt lgkmcnt(1)
  buffer_store_dwordx4 v[44:47], v6, s[36:39], s47 offen sc1
  s_waitcnt lgkmcnt(0)
  buffer_store_dwordx2 v[48:49], v7, s[36:39], s46 offen sc1
  v_lshlrev_b32 v2, 4, v1
  v_add_u32 v3, 41472, v2
  v_lshrrev_b32 v84, 4, v1
  v_and_b32 v85, 7, v1
  v_lshl_add_u32 v84, v84, 3, v85
  v_lshlrev_b32 v84, 4, v84
  v_add_u32 v4, 4096, v84
  v_add_u32 v5, 41472, v4
  v_lshlrev_b32 v6, 4, v1
  s_mul_i32 s62, s48, 4864
  s_add_u32 s62, s62, 83968
  v_and_b32 v84, 15, v1
  v_mul_u32_u24 v84, 304, v84
  v_lshrrev_b32 v85, 4, v1
  v_lshl_add_u32 v84, v85, 4, v84
  v_add_u32 v7, s62, v84
  v_add_u32 v184, s62, v184
  v_add_u32 v185, s62, v185
  v_add_u32 v186, s62, v186
  s_lshl_b32 s62, s49, 7
  s_lshl_b32 s63, s50, 2
  s_add_u32 s62, s62, s63
  s_add_u32 s62, s62, 47104
  s_waitcnt vmcnt(0)
  v_mov_b32 v84, 158212
  v_mov_b32 v85, 1
  s_mov_b64 exec, 1
  ds_add_rtn_u32 v85, v84, v85
  s_waitcnt lgkmcnt(0)
  v_readfirstlane_b32 s63, v85
  s_nop 0
  s_cmp_eq_u32 s63, 3
  s_cselect_b32 s62, s62, 0x7fff0000
  v_mov_b32 v84, s62
  v_mov_b32 v85, s51
  buffer_store_dword v85, v84, s[36:39], 0 offen sc1
  s_mov_b64 exec, -1
  buffer_load_dwordx4 v[160:163], v187, s[28:31], 0 offen
  buffer_load_dwordx2 v[172:173], v8, s[36:39], 0 offen sc1
  buffer_load_dwordx4 v[164:167], v188, s[28:31], 0 offen
  buffer_load_dwordx2 v[176:177], v9, s[36:39], 0 offen sc1
  buffer_load_dwordx4 v[168:171], v189, s[28:31], 0 offen
  buffer_load_dwordx2 v[180:181], v10, s[36:39], 0 offen sc1
  s_lshl_b32 s62, s44, 2
  s_add_u32 s62, s62, s48
  s_mul_i32 s62, s62, 18432
  s_add_u32 s62, s62, 1540096
  s_mov_b32 s40, s22
  s_mov_b32 s41, s23
  s_mov_b32 s42, 2359296
  s_mov_b32 s43, 0x00020000
  v_mov_b32 v84, 158248
  s_mov_b64 exec, 1
  s_mov_b32 s59, 0
Lls_53:
  ds_read_b32 v85, v84
  s_add_u32 s59, s59, 1
  s_cmp_ge_u32 s59, 4000000
  s_waitcnt lgkmcnt(0)
  v_readfirstlane_b32 s63, v85
  s_cbranch_scc1 Llsd_54
  s_cmp_lt_u32 s63, 2
  s_cbranch_scc1 Lls_53
Llsd_54:
  s_mov_b64 exec, -1
  v_mov_b32 v84, 158560
  ds_read_b64 v[86:87], v84
  s_waitcnt lgkmcnt(0)
  v_readfirstlane_b32 s24, v86
  v_mov_b32 v19, v87
  v_mov_b32 v84, 158228
  s_mov_b64 exec, 1
  s_mov_b32 s59, 0
Lls_55:
  ds_read_b32 v85, v84
  s_add_u32 s59, s59, 1
  s_cmp_ge_u32 s59, 4000000
  s_waitcnt lgkmcnt(0)
  v_readfirstlane_b32 s63, v85
  s_cbranch_scc1 Llsd_56
  s_cmp_lt_u32 s63, 2
  s_cbranch_scc1 Lls_55
Llsd_56:
  s_mov_b64 exec, -1
  s_add_u32 s63, s62, 0
  s_nop 1
  buffer_load_dwordx4 v[96:99], v6, s[36:39], s63 offen sc1
  s_add_u32 s63, s62, 1024
  buffer_load_dwordx4 v[100:103], v6, s[36:39], s63 offen sc1
  s_add_u32 s63, s62, 2048
  buffer_load_dwordx4 v[104:107], v6, s[36:39], s63 offen sc1
  s_add_u32 s63, s62, 3072
  buffer_load_dwordx4 v[108:111], v6, s[36:39], s63 offen sc1
  s_add_u32 s63, s62, 4096
  buffer_load_dwordx4 v[112:115], v6, s[36:39], s63 offen sc1
  s_add_u32 s63, s62, 5120
  buffer_load_dwordx4 v[116:119], v6, s[36:39], s63 offen sc1
  s_add_u32 s63, s62, 6144
  buffer_load_dwordx4 v[120:123], v6, s[36:39], s63 offen sc1
  s_add_u32 s63, s62, 7168
  buffer_load_dwordx4 v[124:127], v6, s[36:39], s63 offen sc1
  s_add_u32 s63, s62, 8192
  buffer_load_dwordx4 v[128:131], v6, s[36:39], s63 offen sc1
  s_add_u32 s63, s62, 9216
  buffer_load_dwordx4 v[132:135], v6, s[36:39], s63 offen sc1
  s_add_u32 s63, s62, 10240
  buffer_load_dwordx4 v[136:139], v6, s[36:39], s63 offen sc1
  s_add_u32 s63, s62, 11264
  buffer_load_dwordx4 v[140:143], v6, s[36:39], s63 offen sc1
  s_add_u32 s63, s62, 12288
  buffer_load_dwordx4 v[144:147], v6, s[36:39], s63 offen sc1
  s_add_u32 s63, s62, 13312
  buffer_load_dwordx4 v[148:151], v6, s[36:39], s63 offen sc1
  s_add_u32 s63, s62, 14336
  buffer_load_dwordx4 v[152:155], v6, s[36:39], s63 offen sc1
  s_add_u32 s63, s62, 15360
  buffer_load_dwordx4 v[156:159], v6, s[36:39], s63 offen sc1
  s_add_u32 s63, s62, 16384
  buffer_load_dwordx4 v[192:195], v6, s[36:39], s63 offen sc1
  s_add_u32 s63, s62, 17408
  buffer_load_dwordx4 v[196:199], v6, s[36:39], s63 offen sc1
  ds_read_b128 v[28:31], v2 offset:0
  ds_read_b128 v[32:35], v2 offset:1024
  ds_read_b128 v[36:39], v2 offset:2048
  ds_read_b128 v[40:43], v2 offset:3072
  ds_read_b128 v[44:47], v4 offset:0
  s_waitcnt vmcnt(17)
  s_waitcnt lgkmcnt(4)
  v_mfma_f32_16x16x32_bf16 v[200:203], v[28:31], v[96:99], 0
  ds_read_b128 v[48:51], v2 offset:4608
  s_waitcnt lgkmcnt(4)
  v_mfma_f32_16x16x32_bf16 v[204:207], v[32:35], v[96:99], 0
  ds_read_b128 v[52:55], v2 offset:5632
  s_waitcnt lgkmcnt(4)
  v_mfma_f32_16x16x32_bf16 v[208:211], v[36:39], v[96:99], 0
  ds_read_b128 v[56:59], v2 offset:6656
  s_waitcnt lgkmcnt(4)
  v_mfma_f32_16x16x32_bf16 v[212:215], v[40:43], v[96:99], 0
  ds_read_b128 v[60:63], v2 offset:7680
  s_waitcnt lgkmcnt(4)
  v_mfma_f32_16x16x32_bf16 v[216:219], v[44:47], v[96:99], 0
  ds_read_b128 v[64:67], v4 offset:4608
  s_waitcnt vmcnt(16)
  s_waitcnt lgkmcnt(4)
  v_mfma_f32_16x16x32_bf16 v[200:203], v[48:51], v[100:103], v[200:203]
  ds_read_b128 v[28:31], v2 offset:9216
  s_waitcnt lgkmcnt(4)
  v_mfma_f32_16x16x32_bf16 v[204:207], v[52:55], v[100:103], v[204:207]
  ds_read_b128 v[32:35], v2 offset:10240
  s_waitcnt lgkmcnt(4)
  v_mfma_f32_16x16x32_bf16 v[208:211], v[56:59], v[100:103], v[208:211]
  ds_read_b128 v[36:39], v2 offset:11264
  s_waitcnt lgkmcnt(4)
  v_mfma_f32_16x16x32_bf16 v[212:215], v[60:63], v[100:103], v[212:215]
  ds_read_b128 v[40:43], v2 offset:12288
  s_waitcnt lgkmcnt(4)
  v_mfma_f32_16x16x32_bf16 v[216:219], v[64:67], v[100:103], v[216:219]
  ds_read_b128 v[44:47], v4 offset:9216
  s_waitcnt vmcnt(15)
  s_waitcnt lgkmcnt(4)
  v_mfma_f32_16x16x32_bf16 v[200:203], v[28:31], v[104:107], v[200:203]
  ds_read_b128 v[48:51], v2 offset:13824
  s_waitcnt lgkmcnt(4)
  v_mfma_f32_16x16x32_bf16 v[204:207], v[32:35], v[104:107], v[204:207]
  ds_read_b128 v[52:55], v2 offset:14848
  s_waitcnt lgkmcnt(4)
  v_mfma_f32_16x16x32_bf16 v[208:211], v[36:39], v[104:107], v[208:211]
  ds_read_b128 v[56:59], v2 offset:15872
  s_waitcnt lgkmcnt(4)
  v_mfma_f32_16x16x32_bf16 v[212:215], v[40:43], v[104:107], v[212:215]
  ds_read_b128 v[60:63], v2 offset:16896
  s_waitcnt lgkmcnt(4)
  v_mfma_f32_16x16x32_bf16 v[216:219], v[44:47], v[104:107], v[216:219]
  ds_read_b128 v[64:67], v4 offset:13824
  s_waitcnt vmcnt(14)
  s_waitcnt lgkmcnt(4)
  v_mfma_f32_16x16x32_bf16 v[200:203], v[48:51], v[108:111], v[200:203]
  ds_read_b128 v[28:31], v2 offset:18432
  s_waitcnt lgkmcnt(4)
  v_mfma_f32_16x16x32_bf16 v[204:207], v[52:55], v[108:111], v[204:207]
  ds_read_b128 v[32:35], v2 offset:19456
  s_waitcnt lgkmcnt(4)
  v_mfma_f32_16x16x32_bf16 v[208:211], v[56:59], v[108:111], v[208:211]
  ds_read_b128 v[36:39], v2 offset:20480
  s_waitcnt lgkmcnt(4)
  v_mfma_f32_16x16x32_bf16 v[212:215], v[60:63], v[108:111], v[212:215]
  ds_read_b128 v[40:43], v2 offset:21504
  s_waitcnt lgkmcnt(4)
  v_mfma_f32_16x16x32_bf16 v[216:219], v[64:67], v[108:111], v[216:219]
  ds_read_b128 v[44:47], v4 offset:18432
  s_waitcnt vmcnt(13)
  s_waitcnt lgkmcnt(4)
  v_mfma_f32_16x16x32_bf16 v[200:203], v[28:31], v[112:115], v[200:203]
  ds_read_b128 v[48:51], v2 offset:23040
  s_waitcnt lgkmcnt(4)
  v_mfma_f32_16x16x32_bf16 v[204:207], v[32:35], v[112:115], v[204:207]
  ds_read_b128 v[52:55], v2 offset:24064
  s_waitcnt lgkmcnt(4)
  v_mfma_f32_16x16x32_bf16 v[208:211], v[36:39], v[112:115], v[208:211]
  ds_read_b128 v[56:59], v2 offset:25088
  s_waitcnt lgkmcnt(4)
  v_mfma_f32_16x16x32_bf16 v[212:215], v[40:43], v[112:115], v[212:215]
  ds_read_b128 v[60:63], v2 offset:26112
  s_waitcnt lgkmcnt(4)
  v_mfma_f32_16x16x32_bf16 v[216:219], v[44:47], v[112:115], v[216:219]
  ds_read_b128 v[64:67], v4 offset:23040
  s_waitcnt vmcnt(12)
  s_waitcnt lgkmcnt(4)
  v_mfma_f32_16x16x32_bf16 v[200:203], v[48:51], v[116:119], v[200:203]
  ds_read_b128 v[28:31], v2 offset:27648
  s_waitcnt lgkmcnt(4)
  v_mfma_f32_16x16x32_bf16 v[204:207], v[52:55], v[116:119], v[204:207]
  ds_read_b128 v[32:35], v2 offset:28672
  s_waitcnt lgkmcnt(4)
  v_mfma_f32_16x16x32_bf16 v[208:211], v[56:59], v[116:119], v[208:211]
  ds_read_b128 v[36:39], v2 offset:29696
  s_waitcnt lgkmcnt(4)
  v_mfma_f32_16x16x32_bf16 v[212:215], v[60:63], v[116:119], v[212:215]
  ds_read_b128 v[40:43], v2 offset:30720
  s_waitcnt lgkmcnt(4)
  v_mfma_f32_16x16x32_bf16 v[216:219], v[64:67], v[116:119], v[216:219]
  ds_read_b128 v[44:47], v4 offset:27648
  s_waitcnt vmcnt(11)
  s_waitcnt lgkmcnt(4)
  v_mfma_f32_16x16x32_bf16 v[200:203], v[28:31], v[120:123], v[200:203]
  ds_read_b128 v[48:51], v2 offset:32256
  s_waitcnt lgkmcnt(4)
  v_mfma_f32_16x16x32_bf16 v[204:207], v[32:35], v[120:123], v[204:207]
  ds_read_b128 v[52:55], v2 offset:33280
  s_waitcnt lgkmcnt(4)
  v_mfma_f32_16x16x32_bf16 v[208:211], v[36:39], v[120:123], v[208:211]
  ds_read_b128 v[56:59], v2 offset:34304
  s_waitcnt lgkmcnt(4)
  v_mfma_f32_16x16x32_bf16 v[212:215], v[40:43], v[120:123], v[212:215]
  ds_read_b128 v[60:63], v2 offset:35328
  s_waitcnt lgkmcnt(4)
  v_mfma_f32_16x16x32_bf16 v[216:219], v[44:47], v[120:123], v[216:219]
  ds_read_b128 v[64:67], v4 offset:32256
  s_waitcnt vmcnt(10)
  s_waitcnt lgkmcnt(4)
  v_mfma_f32_16x16x32_bf16 v[200:203], v[48:51], v[124:127], v[200:203]
  ds_read_b128 v[28:31], v2 offset:36864
  s_waitcnt lgkmcnt(4)
  v_mfma_f32_16x16x32_bf16 v[204:207], v[52:55], v[124:127], v[204:207]
  ds_read_b128 v[32:35], v2 offset:37888
  s_waitcnt lgkmcnt(4)
  v_mfma_f32_16x16x32_bf16 v[208:211], v[56:59], v[124:127], v[208:211]
  ds_read_b128 v[36:39], v2 offset:38912
  s_waitcnt lgkmcnt(4)
  v_mfma_f32_16x16x32_bf16 v[212:215], v[60:63], v[124:127], v[212:215]
  ds_read_b128 v[40:43], v2 offset:39936
  s_waitcnt lgkmcnt(4)
  v_mfma_f32_16x16x32_bf16 v[216:219], v[64:67], v[124:127], v[216:219]
  ds_read_b128 v[44:47], v4 offset:36864
  s_waitcnt vmcnt(9)
  s_waitcnt lgkmcnt(4)
  v_mfma_f32_16x16x32_bf16 v[200:203], v[28:31], v[128:131], v[200:203]
  ds_read_b128 v[48:51], v3 offset:0
  s_waitcnt lgkmcnt(4)
  v_mfma_f32_16x16x32_bf16 v[204:207], v[32:35], v[128:131], v[204:207]
  ds_read_b128 v[52:55], v3 offset:1024
  s_waitcnt lgkmcnt(4)
  v_mfma_f32_16x16x32_bf16 v[208:211], v[36:39], v[128:131], v[208:211]
  ds_read_b128 v[56:59], v3 offset:2048
  s_waitcnt lgkmcnt(4)
  v_mfma_f32_16x16x32_bf16 v[212:215], v[40:43], v[128:131], v[212:215]
  ds_read_b128 v[60:63], v3 offset:3072
  s_waitcnt lgkmcnt(4)
  v_mfma_f32_16x16x32_bf16 v[216:219], v[44:47], v[128:131], v[216:219]
  ds_read_b128 v[64:67], v5 offset:0
  s_waitcnt vmcnt(8)
  s_waitcnt lgkmcnt(4)
  v_mfma_f32_16x16x32_bf16 v[200:203], v[48:51], v[132:135], v[200:203]
  ds_read_b128 v[28:31], v3 offset:4608
  s_waitcnt lgkmcnt(4)
  v_mfma_f32_16x16x32_bf16 v[204:207], v[52:55], v[132:135], v[204:207]
  ds_read_b128 v[32:35], v3 offset:5632
  s_waitcnt lgkmcnt(4)
  v_mfma_f32_16x16x32_bf16 v[208:211], v[56:59], v[132:135], v[208:211]
  ds_read_b128 v[36:39], v3 offset:6656
  s_waitcnt lgkmcnt(4)
  v_mfma_f32_16x16x32_bf16 v[212:215], v[60:63], v[132:135], v[212:215]
  ds_read_b128 v[40:43], v3 offset:7680
  s_waitcnt lgkmcnt(4)
  v_mfma_f32_16x16x32_bf16 v[216:219], v[64:67], v[132:135], v[216:219]
  ds_read_b128 v[44:47], v5 offset:4608
  s_waitcnt vmcnt(7)
  s_waitcnt lgkmcnt(4)
  v_mfma_f32_16x16x32_bf16 v[200:203], v[28:31], v[136:139], v[200:203]
  ds_read_b128 v[48:51], v3 offset:9216
  s_waitcnt lgkmcnt(4)
  v_mfma_f32_16x16x32_bf16 v[204:207], v[32:35], v[136:139], v[204:207]
  ds_read_b128 v[52:55], v3 offset:10240
  s_waitcnt lgkmcnt(4)
  v_mfma_f32_16x16x32_bf16 v[208:211], v[36:39], v[136:139], v[208:211]
  ds_read_b128 v[56:59], v3 offset:11264
  s_waitcnt lgkmcnt(4)
  v_mfma_f32_16x16x32_bf16 v[212:215], v[40:43], v[136:139], v[212:215]
  ds_read_b128 v[60:63], v3 offset:12288
  s_waitcnt lgkmcnt(4)
  v_mfma_f32_16x16x32_bf16 v[216:219], v[44:47], v[136:139], v[216:219]
  ds_read_b128 v[64:67], v5 offset:9216
  s_waitcnt vmcnt(6)
  s_waitcnt lgkmcnt(4)
  v_mfma_f32_16x16x32_bf16 v[200:203], v[48:51], v[140:143], v[200:203]
  ds_read_b128 v[28:31], v3 offset:13824
  s_waitcnt lgkmcnt(4)
  v_mfma_f32_16x16x32_bf16 v[204:207], v[52:55], v[140:143], v[204:207]
  ds_read_b128 v[32:35], v3 offset:14848
  s_waitcnt lgkmcnt(4)
  v_mfma_f32_16x16x32_bf16 v[208:211], v[56:59], v[140:143], v[208:211]
  ds_read_b128 v[36:39], v3 offset:15872
  s_waitcnt lgkmcnt(4)
  v_mfma_f32_16x16x32_bf16 v[212:215], v[60:63], v[140:143], v[212:215]
  ds_read_b128 v[40:43], v3 offset:16896
  s_waitcnt lgkmcnt(4)
  v_mfma_f32_16x16x32_bf16 v[216:219], v[64:67], v[140:143], v[216:219]
  ds_read_b128 v[44:47], v5 offset:13824
  s_waitcnt vmcnt(5)
  s_waitcnt lgkmcnt(4)
  v_mfma_f32_16x16x32_bf16 v[200:203], v[28:31], v[144:147], v[200:203]
  ds_read_b128 v[48:51], v3 offset:18432
  s_waitcnt lgkmcnt(4)
  v_mfma_f32_16x16x32_bf16 v[204:207], v[32:35], v[144:147], v[204:207]
  ds_read_b128 v[52:55], v3 offset:19456
  s_waitcnt lgkmcnt(4)
  v_mfma_f32_16x16x32_bf16 v[208:211], v[36:39], v[144:147], v[208:211]
  ds_read_b128 v[56:59], v3 offset:20480
  s_waitcnt lgkmcnt(4)
  v_mfma_f32_16x16x32_bf16 v[212:215], v[40:43], v[144:147], v[212:215]
  ds_read_b128 v[60:63], v3 offset:21504
  s_waitcnt lgkmcnt(4)
  v_mfma_f32_16x16x32_bf16 v[216:219], v[44:47], v[144:147], v[216:219]
  ds_read_b128 v[64:67], v5 offset:18432
  s_waitcnt vmcnt(4)
  s_waitcnt lgkmcnt(4)
  v_mfma_f32_16x16x32_bf16 v[200:203], v[48:51], v[148:151], v[200:203]
  ds_read_b128 v[28:31], v3 offset:23040
  s_waitcnt lgkmcnt(4)
  v_mfma_f32_16x16x32_bf16 v[204:207], v[52:55], v[148:151], v[204:207]
  ds_read_b128 v[32:35], v3 offset:24064
  s_waitcnt lgkmcnt(4)
  v_mfma_f32_16x16x32_bf16 v[208:211], v[56:59], v[148:151], v[208:211]
  ds_read_b128 v[36:39], v3 offset:25088
  s_waitcnt lgkmcnt(4)
  v_mfma_f32_16x16x32_bf16 v[212:215], v[60:63], v[148:151], v[212:215]
  ds_read_b128 v[40:43], v3 offset:26112
  s_waitcnt lgkmcnt(4)
  v_mfma_f32_16x16x32_bf16 v[216:219], v[64:67], v[148:151], v[216:219]
  ds_read_b128 v[44:47], v5 offset:23040
  s_waitcnt vmcnt(3)
  s_waitcnt lgkmcnt(4)
  v_mfma_f32_16x16x32_bf16 v[200:203], v[28:31], v[152:155], v[200:203]
  ds_read_b128 v[48:51], v3 offset:27648
  s_waitcnt lgkmcnt(4)
  v_mfma_f32_16x16x32_bf16 v[204:207], v[32:35], v[152:155], v[204:207]
  ds_read_b128 v[52:55], v3 offset:28672
  s_waitcnt lgkmcnt(4)
  v_mfma_f32_16x16x32_bf16 v[208:211], v[36:39], v[152:155], v[208:211]
  ds_read_b128 v[56:59], v3 offset:29696
  s_waitcnt lgkmcnt(4)
  v_mfma_f32_16x16x32_bf16 v[212:215], v[40:43], v[152:155], v[212:215]
  ds_read_b128 v[60:63], v3 offset:30720
  s_waitcnt lgkmcnt(4)
  v_mfma_f32_16x16x32_bf16 v[216:219], v[44:47], v[152:155], v[216:219]
  ds_read_b128 v[64:67], v5 offset:27648
  s_waitcnt vmcnt(2)
  s_waitcnt lgkmcnt(4)
  v_mfma_f32_16x16x32_bf16 v[200:203], v[48:51], v[156:159], v[200:203]
  ds_read_b128 v[28:31], v3 offset:32256
  s_waitcnt lgkmcnt(4)
  v_mfma_f32_16x16x32_bf16 v[204:207], v[52:55], v[156:159], v[204:207]
  ds_read_b128 v[32:35], v3 offset:33280
  s_waitcnt lgkmcnt(4)
  v_mfma_f32_16x16x32_bf16 v[208:211], v[56:59], v[156:159], v[208:211]
  ds_read_b128 v[36:39], v3 offset:34304
  s_waitcnt lgkmcnt(4)
  v_mfma_f32_16x16x32_bf16 v[212:215], v[60:63], v[156:159], v[212:215]
  ds_read_b128 v[40:43], v3 offset:35328
  s_waitcnt lgkmcnt(4)
  v_mfma_f32_16x16x32_bf16 v[216:219], v[64:67], v[156:159], v[216:219]
  ds_read_b128 v[44:47], v5 offset:32256
  s_waitcnt vmcnt(1)
  s_waitcnt lgkmcnt(4)
  v_mfma_f32_16x16x32_bf16 v[200:203], v[28:31], v[192:195], v[200:203]
  ds_read_b128 v[48:51], v3 offset:36864
  s_waitcnt lgkmcnt(4)
  v_mfma_f32_16x16x32_bf16 v[204:207], v[32:35], v[192:195], v[204:207]
  ds_read_b128 v[52:55], v3 offset:37888
  s_waitcnt lgkmcnt(4)
  v_mfma_f32_16x16x32_bf16 v[208:211], v[36:39], v[192:195], v[208:211]
  ds_read_b128 v[56:59], v3 offset:38912
  s_waitcnt lgkmcnt(4)
  v_mfma_f32_16x16x32_bf16 v[212:215], v[40:43], v[192:195], v[212:215]
  ds_read_b128 v[60:63], v3 offset:39936
  s_waitcnt lgkmcnt(4)
  v_mfma_f32_16x16x32_bf16 v[216:219], v[44:47], v[192:195], v[216:219]
  ds_read_b128 v[64:67], v5 offset:36864
  s_waitcnt vmcnt(0)
  s_waitcnt lgkmcnt(4)
  v_mfma_f32_16x16x32_bf16 v[200:203], v[48:51], v[196:199], v[200:203]
  s_waitcnt lgkmcnt(3)
  v_mfma_f32_16x16x32_bf16 v[204:207], v[52:55], v[196:199], v[204:207]
  s_waitcnt lgkmcnt(2)
  v_mfma_f32_16x16x32_bf16 v[208:211], v[56:59], v[196:199], v[208:211]
  s_waitcnt lgkmcnt(1)
  v_mfma_f32_16x16x32_bf16 v[212:215], v[60:63], v[196:199], v[212:215]
  s_waitcnt lgkmcnt(0)
  v_mfma_f32_16x16x32_bf16 v[216:219], v[64:67], v[196:199], v[216:219]
  v_add_f32 v174, 1.0, v173
  v_mul_f32 v175, v172, v173
  v_add_f32 v178, 1.0, v177
  v_mul_f32 v179, v176, v177
  v_add_f32 v182, 1.0, v181
  v_mul_f32 v183, v180, v181
  ds_write_b128 v7, v[200:203] offset:0
  ds_write_b128 v7, v[204:207] offset:64
  ds_write_b128 v7, v[208:211] offset:128
  ds_write_b128 v7, v[212:215] offset:192
  s_mov_b32 exec_hi, 0
  ds_write_b128 v7, v[216:219] offset:256
  s_mov_b32 exec_hi, -1
  s_waitcnt lgkmcnt(0)
  ds_read_b128 v[28:31], v184
  ds_read_b128 v[32:35], v184 offset:16
  ds_read_b128 v[36:39], v185
  ds_read_b128 v[40:43], v185 offset:16
  ds_read_b128 v[44:47], v186
  ds_read_b128 v[48:51], v186 offset:16
  v_lshlrev_b32 v96, 16, v160
  v_and_b32 v97, 0xffff0000, v160
  v_lshlrev_b32 v98, 16, v161
  v_and_b32 v99, 0xffff0000, v161
  v_lshlrev_b32 v100, 16, v162
  v_and_b32 v101, 0xffff0000, v162
  v_lshlrev_b32 v102, 16, v163
  v_and_b32 v103, 0xffff0000, v163
  v_pk_fma_f32 v[96:97], v[96:97], v[174:175], v[174:175] op_sel:[0,0,1] op_sel_hi:[1,0,1] neg_lo:[0,0,1] neg_hi:[0,0,1]
  v_pk_fma_f32 v[98:99], v[98:99], v[174:175], v[174:175] op_sel:[0,0,1] op_sel_hi:[1,0,1] neg_lo:[0,0,1] neg_hi:[0,0,1]
  v_pk_fma_f32 v[100:101], v[100:101], v[174:175], v[174:175] op_sel:[0,0,1] op_sel_hi:[1,0,1] neg_lo:[0,0,1] neg_hi:[0,0,1]
  v_pk_fma_f32 v[102:103], v[102:103], v[174:175], v[174:175] op_sel:[0,0,1] op_sel_hi:[1,0,1] neg_lo:[0,0,1] neg_hi:[0,0,1]
  v_lshlrev_b32 v104, 16, v164
  v_and_b32 v105, 0xffff0000, v164
  v_lshlrev_b32 v106, 16, v165
  v_and_b32 v107, 0xffff0000, v165
  v_lshlrev_b32 v108, 16, v166
  v_and_b32 v109, 0xffff0000, v166
  v_lshlrev_b32 v110, 16, v167
  v_and_b32 v111, 0xffff0000, v167
  v_pk_fma_f32 v[104:105], v[104:105], v[178:179], v[178:179] op_sel:[0,0,1] op_sel_hi:[1,0,1] neg_lo:[0,0,1] neg_hi:[0,0,1]
  v_pk_fma_f32 v[106:107], v[106:107], v[178:179], v[178:179] op_sel:[0,0,1] op_sel_hi:[1,0,1] neg_lo:[0,0,1] neg_hi:[0,0,1]
  v_pk_fma_f32 v[108:109], v[108:109], v[178:179], v[178:179] op_sel:[0,0,1] op_sel_hi:[1,0,1] neg_lo:[0,0,1] neg_hi:[0,0,1]
  v_pk_fma_f32 v[110:111], v[110:111], v[178:179], v[178:179] op_sel:[0,0,1] op_sel_hi:[1,0,1] neg_lo:[0,0,1] neg_hi:[0,0,1]
  v_lshlrev_b32 v112, 16, v168
  v_and_b32 v113, 0xffff0000, v168
  v_lshlrev_b32 v114, 16, v169
  v_and_b32 v115, 0xffff0000, v169
  v_lshlrev_b32 v116, 16, v170
  v_and_b32 v117, 0xffff0000, v170
  v_lshlrev_b32 v118, 16, v171
  v_and_b32 v119, 0xffff0000, v171
  v_pk_fma_f32 v[112:113], v[112:113], v[182:183], v[182:183] op_sel:[0,0,1] op_sel_hi:[1,0,1] neg_lo:[0,0,1] neg_hi:[0,0,1]
  v_pk_fma_f32 v[114:115], v[114:115], v[182:183], v[182:183] op_sel:[0,0,1] op_sel_hi:[1,0,1] neg_lo:[0,0,1] neg_hi:[0,0,1]
  v_pk_fma_f32 v[116:117], v[116:117], v[182:183], v[182:183] op_sel:[0,0,1] op_sel_hi:[1,0,1] neg_lo:[0,0,1] neg_hi:[0,0,1]
  v_pk_fma_f32 v[118:119], v[118:119], v[182:183], v[182:183] op_sel:[0,0,1] op_sel_hi:[1,0,1] neg_lo:[0,0,1] neg_hi:[0,0,1]
  s_lshr_b32 s63, s24, 6
  s_mov_b32 s62, s24
  s_cmp_eq_u32 s63, s44
  s_cbranch_scc0 Lnoy_57
  s_waitcnt lgkmcnt(0)
  v_mov_b32 v84, 158240
  s_mov_b64 exec, 1
  s_mov_b32 s59, 0
Lls_58:
  ds_read_b32 v85, v84
  s_add_u32 s59, s59, 1
  s_cmp_ge_u32 s59, 4000000
  s_waitcnt lgkmcnt(0)
  v_readfirstlane_b32 s63, v85
  s_cbranch_scc1 Llsd_59
  s_cmp_lt_u32 s63, 2
  s_cbranch_scc1 Lls_58
Llsd_59:
  s_mov_b64 exec, -1
  s_mov_b32 s62, s24
  s_lshl_b32 s63, s44, 6
  s_sub_u32 s62, s62, s63
  s_lshl_b32 s63, s48, 4
  s_sub_u32 s62, s62, s63
  v_add_u32 v84, 0, v1
  v_mul_u32_u24 v85, 7282, v84
  v_lshrrev_b32 v85, 16, v85
  v_mul_u32_u24 v88, 9, v85
  v_sub_u32 v88, v84, v88
  v_lshlrev_b32 v88, 5, v88
  v_add_u32 v88, 158272, v88
  ds_read_b128 v[120:123], v88
  ds_read_b128 v[124:127], v88 offset:16
  v_cmp_eq_u32 vcc, s62, v85
  s_nop 1
  v_cndmask_b32 v89, 0, v19, vcc
  s_waitcnt lgkmcnt(0)
  v_fmac_f32 v96, v120, v89
  v_fmac_f32 v97, v121, v89
  v_fmac_f32 v98, v122, v89
  v_fmac_f32 v99, v123, v89
  v_fmac_f32 v100, v124, v89
  v_fmac_f32 v101, v125, v89
  v_fmac_f32 v102, v126, v89
  v_fmac_f32 v103, v127, v89
  v_add_u32 v84, 64, v1
  v_mul_u32_u24 v85, 7282, v84
  v_lshrrev_b32 v85, 16, v85
  v_mul_u32_u24 v88, 9, v85
  v_sub_u32 v88, v84, v88
  v_lshlrev_b32 v88, 5, v88
  v_add_u32 v88, 158272, v88
  ds_read_b128 v[120:123], v88
  ds_read_b128 v[124:127], v88 offset:16
  v_cmp_eq_u32 vcc, s62, v85
  s_nop 1
  v_cndmask_b32 v89, 0, v19, vcc
  s_waitcnt lgkmcnt(0)
  v_fmac_f32 v104, v120, v89
  v_fmac_f32 v105, v121, v89
  v_fmac_f32 v106, v122, v89
  v_fmac_f32 v107, v123, v89
  v_fmac_f32 v108, v124, v89
  v_fmac_f32 v109, v125, v89
  v_fmac_f32 v110, v126, v89
  v_fmac_f32 v111, v127, v89
  v_add_u32 v84, 128, v1
  v_mul_u32_u24 v85, 7282, v84
  v_lshrrev_b32 v85, 16, v85
  v_mul_u32_u24 v88, 9, v85
  v_sub_u32 v88, v84, v88
  v_lshlrev_b32 v88, 5, v88
  v_add_u32 v88, 158272, v88
  ds_read_b128 v[120:123], v88
  ds_read_b128 v[124:127], v88 offset:16
  v_cmp_eq_u32 vcc, s62, v85
  s_nop 1
  v_cndmask_b32 v89, 0, v19, vcc
  s_waitcnt lgkmcnt(0)
  v_fmac_f32 v112, v120, v89
  v_fmac_f32 v113, v121, v89
  v_fmac_f32 v114, v122, v89
  v_fmac_f32 v115, v123, v89
  v_fmac_f32 v116, v124, v89
  v_fmac_f32 v117, v125, v89
  v_fmac_f32 v118, v126, v89
  v_fmac_f32 v119, v127, v89
Lnoy_57:
  s_waitcnt lgkmcnt(4)
  v_pk_add_f32 v[28:29], v[28:29], v[96:97]
  v_pk_add_f32 v[30:31], v[30:31], v[98:99]
  v_pk_add_f32 v[32:33], v[32:33], v[100:101]
  v_pk_add_f32 v[34:35], v[34:35], v[102:103]
  v_cvt_pk_bf16_f32 v160, v28, v29
  v_cvt_pk_bf16_f32 v161, v30, v31
  v_cvt_pk_bf16_f32 v162, v32, v33
  v_cvt_pk_bf16_f32 v163, v34, v35
  buffer_store_dwordx4 v[160:163], v187, s[40:43], 0 offen
  s_waitcnt lgkmcnt(2)
  v_pk_add_f32 v[36:37], v[36:37], v[104:105]
  v_pk_add_f32 v[38:39], v[38:39], v[106:107]
  v_pk_add_f32 v[40:41], v[40:41], v[108:109]
  v_pk_add_f32 v[42:43], v[42:43], v[110:111]
  v_cvt_pk_bf16_f32 v164, v36, v37
  v_cvt_pk_bf16_f32 v165, v38, v39
  v_cvt_pk_bf16_f32 v166, v40, v41
  v_cvt_pk_bf16_f32 v167, v42, v43
  buffer_store_dwordx4 v[164:167], v188, s[40:43], 0 offen
  s_waitcnt lgkmcnt(0)
  v_pk_add_f32 v[44:45], v[44:45], v[112:113]
  v_pk_add_f32 v[46:47], v[46:47], v[114:115]
  v_pk_add_f32 v[48:49], v[48:49], v[116:117]
  v_pk_add_f32 v[50:51], v[50:51], v[118:119]
  v_cvt_pk_bf16_f32 v168, v44, v45
  v_cvt_pk_bf16_f32 v169, v46, v47
  v_cvt_pk_bf16_f32 v170, v48, v49
  v_cvt_pk_bf16_f32 v171, v50, v51
  buffer_store_dwordx4 v[168:171], v189, s[40:43], 0 offen
  s_cmp_eq_u32 s60, 0
  s_cbranch_scc0 L_fin
  s_cmp_eq_u32 s48, 0
  s_cbranch_scc0 L_fin
  v_mov_b32 v200, s51
  v_mov_b32 v201, 0
  s_mov_b64 exec, 1
  buffer_store_dword v200, v201, s[36:39], 0 offen sc1
L_fin:
  s_waitcnt vmcnt(0)
  s_endpgm
L_helper:
  s_sub_u32 s47, s48, 4
  s_cmp_ge_u32 s47, 2
  s_cbranch_scc1 L_moe
  s_lshl_b32 s54, s47, 13
  v_lshrrev_b32 v5, 3, v1
  s_lshl_b32 s57, s49, 7
  s_lshl_b32 s58, s47, 6
  s_add_u32 s57, s57, s58
  v_add_u32 v5, s57, v5
  v_mul_u32_u24 v5, 1152, v5
  v_lshrrev_b32 v6, 4, v1
  v_and_b32 v7, 7, v1
  v_xor_b32 v8, v7, v6
  v_lshl_add_u32 v2, v8, 4, v5
  v_xor_b32 v8, 4, v8
  v_lshl_add_u32 v3, v8, 4, v5
  v_lshlrev_b32 v7, 2, v6
  v_sub_u32 v7, v1, v7
  v_and_b32 v7, 15, v7
  v_min_u32 v7, 14, v7
  v_mul_u32_u24 v8, 52, v7
  v_lshrrev_b32 v8, 8, v8
  v_mul_u32_u24 v9, 5, v8
  v_sub_u32 v9, v7, v9
  v_mul_u32_u24 v6, 3456, v6
  v_mul_u32_u24 v8, 1152, v8
  v_add_u32 v6, v6, v8
  v_lshl_add_u32 v6, v9, 4, v6
  s_mul_i32 s57, s50, 72
  s_and_b32 s57, s57, 0xfffffff0
  s_mul_i32 s58, s47, 110592
  s_add_u32 s57, s57, s58
  v_add_u32 v4, s57, v6
  s_waitcnt lgkmcnt(0)
  s_mov_b32 s28, s4
  s_mov_b32 s29, s5
  s_mov_b32 s30, 2359296
  s_mov_b32 s31, 0x00020000
  s_mov_b32 s36, s26
  s_mov_b32 s37, s27
  s_mov_b32 s38, 33554432
  s_mov_b32 s39, 0x00020000
  s_mov_b32 s32, s6
  s_mov_b32 s33, s7
  s_mov_b32 s34, 1990656
  s_mov_b32 s35, 0x00020000
  s_add_u32 s53, s52, 0
  s_cmp_ge_u32 s53, 9
  s_cselect_b32 s57, 9, 0
  s_sub_u32 s53, s53, s57
  s_lshl_b32 s55, s53, 7
  s_mul_i32 s56, s53, 221184
  s_add_u32 m0, s54, 16384
  s_add_u32 s58, s56, 0
  buffer_load_dwordx4 v4, s[32:35], s58 offen lds
  s_add_u32 m0, s54, 0
  s_add_u32 s57, s55, 0
  buffer_load_dwordx4 v2, s[28:31], s57 offen lds
  s_add_u32 m0, s54, 17408
  s_add_u32 s58, s56, 13824
  buffer_load_dwordx4 v4, s[32:35], s58 offen lds
  s_add_u32 m0, s54, 1024
  s_add_u32 s57, s55, 9216
  buffer_load_dwordx4 v3, s[28:31], s57 offen lds
  s_add_u32 m0, s54, 18432
  s_add_u32 s58, s56, 27648
  buffer_load_dwordx4 v4, s[32:35], s58 offen lds
  s_add_u32 m0, s54, 2048
  s_add_u32 s57, s55, 18432
  buffer_load_dwordx4 v2, s[28:31], s57 offen lds
  s_add_u32 m0, s54, 19456
  s_add_u32 s58, s56, 41472
  buffer_load_dwordx4 v4, s[32:35], s58 offen lds
  s_add_u32 m0, s54, 3072
  s_add_u32 s57, s55, 27648
  buffer_load_dwordx4 v3, s[28:31], s57 offen lds
  s_add_u32 m0, s54, 20480
  s_add_u32 s58, s56, 55296
  buffer_load_dwordx4 v4, s[32:35], s58 offen lds
  s_add_u32 m0, s54, 4096
  s_add_u32 s57, s55, 36864
  buffer_load_dwordx4 v2, s[28:31], s57 offen lds
  s_add_u32 m0, s54, 21504
  s_add_u32 s58, s56, 69120
  buffer_load_dwordx4 v4, s[32:35], s58 offen lds
  s_add_u32 m0, s54, 5120
  s_add_u32 s57, s55, 46080
  buffer_load_dwordx4 v3, s[28:31], s57 offen lds
  s_add_u32 m0, s54, 22528
  s_add_u32 s58, s56, 82944
  buffer_load_dwordx4 v4, s[32:35], s58 offen lds
  s_add_u32 m0, s54, 6144
  s_add_u32 s57, s55, 55296
  buffer_load_dwordx4 v2, s[28:31], s57 offen lds
  s_add_u32 m0, s54, 23552
  s_add_u32 s58, s56, 96768
  buffer_load_dwordx4 v4, s[32:35], s58 offen lds
  s_add_u32 m0, s54, 7168
  s_add_u32 s57, s55, 64512
  buffer_load_dwordx4 v3, s[28:31], s57 offen lds
  s_add_u32 s53, s52, 1
  s_cmp_ge_u32 s53, 9
  s_cselect_b32 s57, 9, 0
  s_sub_u32 s53, s53, s57
  s_lshl_b32 s55, s53, 7
  s_mul_i32 s56, s53, 221184
  s_add_u32 m0, s54, 49152
  s_add_u32 s58, s56, 0
  buffer_load_dwordx4 v4, s[32:35], s58 offen lds
  s_add_u32 m0, s54, 32768
  s_add_u32 s57, s55, 0
  buffer_load_dwordx4 v2, s[28:31], s57 offen lds
  s_add_u32 m0, s54, 50176
  s_add_u32 s58, s56, 13824
  buffer_load_dwordx4 v4, s[32:35], s58 offen lds
  s_add_u32 m0, s54, 33792
  s_add_u32 s57, s55, 9216
  buffer_load_dwordx4 v3, s[28:31], s57 offen lds
  s_add_u32 m0, s54, 51200
  s_add_u32 s58, s56, 27648
  buffer_load_dwordx4 v4, s[32:35], s58 offen lds
  s_add_u32 m0, s54, 34816
  s_add_u32 s57, s55, 18432
  buffer_load_dwordx4 v2, s[28:31], s57 offen lds
  s_add_u32 m0, s54, 52224
  s_add_u32 s58, s56, 41472
  buffer_load_dwordx4 v4, s[32:35], s58 offen lds
  s_add_u32 m0, s54, 35840
  s_add_u32 s57, s55, 27648
  buffer_load_dwordx4 v3, s[28:31], s57 offen lds
  s_add_u32 m0, s54, 53248
  s_add_u32 s58, s56, 55296
  buffer_load_dwordx4 v4, s[32:35], s58 offen lds
  s_add_u32 m0, s54, 36864
  s_add_u32 s57, s55, 36864
  buffer_load_dwordx4 v2, s[28:31], s57 offen lds
  s_add_u32 m0, s54, 54272
  s_add_u32 s58, s56, 69120
  buffer_load_dwordx4 v4, s[32:35], s58 offen lds
  s_add_u32 m0, s54, 37888
  s_add_u32 s57, s55, 46080
  buffer_load_dwordx4 v3, s[28:31], s57 offen lds
  s_add_u32 m0, s54, 55296
  s_add_u32 s58, s56, 82944
  buffer_load_dwordx4 v4, s[32:35], s58 offen lds
  s_add_u32 m0, s54, 38912
  s_add_u32 s57, s55, 55296
  buffer_load_dwordx4 v2, s[28:31], s57 offen lds
  s_add_u32 m0, s54, 56320
  s_add_u32 s58, s56, 96768
  buffer_load_dwordx4 v4, s[32:35], s58 offen lds
  s_add_u32 m0, s54, 39936
  s_add_u32 s57, s55, 64512
  buffer_load_dwordx4 v3, s[28:31], s57 offen lds
  s_waitcnt vmcnt(16)
  s_barrier
  s_add_u32 s53, s52, 2
  s_cmp_ge_u32 s53, 9
  s_cselect_b32 s57, 9, 0
  s_sub_u32 s53, s53, s57
  s_lshl_b32 s55, s53, 7
  s_mul_i32 s56, s53, 221184
  s_add_u32 m0, s54, 81920
  s_add_u32 s58, s56, 0
  buffer_load_dwordx4 v4, s[32:35], s58 offen lds
  s_add_u32 m0, s54, 65536
  s_add_u32 s57, s55, 0
  buffer_load_dwordx4 v2, s[28:31], s57 offen lds
  s_add_u32 m0, s54, 82944
  s_add_u32 s58, s56, 13824
  buffer_load_dwordx4 v4, s[32:35], s58 offen lds
  s_add_u32 m0, s54, 66560
  s_add_u32 s57, s55, 9216
  buffer_load_dwordx4 v3, s[28:31], s57 offen lds
  s_add_u32 m0, s54, 83968
  s_add_u32 s58, s56, 27648
  buffer_load_dwordx4 v4, s[32:35], s58 offen lds
  s_add_u32 m0, s54, 67584
  s_add_u32 s57, s55, 18432
  buffer_load_dwordx4 v2, s[28:31], s57 offen lds
  s_add_u32 m0, s54, 84992
  s_add_u32 s58, s56, 41472
  buffer_load_dwordx4 v4, s[32:35], s58 offen lds
  s_add_u32 m0, s54, 68608
  s_add_u32 s57, s55, 27648
  buffer_load_dwordx4 v3, s[28:31], s57 offen lds
  s_add_u32 m0, s54, 86016
  s_add_u32 s58, s56, 55296
  buffer_load_dwordx4 v4, s[32:35], s58 offen lds
  s_add_u32 m0, s54, 69632
  s_add_u32 s57, s55, 36864
  buffer_load_dwordx4 v2, s[28:31], s57 offen lds
  s_add_u32 m0, s54, 87040
  s_add_u32 s58, s56, 69120
  buffer_load_dwordx4 v4, s[32:35], s58 offen lds
  s_add_u32 m0, s54, 70656
  s_add_u32 s57, s55, 46080
  buffer_load_dwordx4 v3, s[28:31], s57 offen lds
  s_add_u32 m0, s54, 88064
  s_add_u32 s58, s56, 82944
  buffer_load_dwordx4 v4, s[32:35], s58 offen lds
  s_add_u32 m0, s54, 71680
  s_add_u32 s57, s55, 55296
  buffer_load_dwordx4 v2, s[28:31], s57 offen lds
  s_add_u32 m0, s54, 89088
  s_add_u32 s58, s56, 96768
  buffer_load_dwordx4 v4, s[32:35], s58 offen lds
  s_add_u32 m0, s54, 72704
  s_add_u32 s57, s55, 64512
  buffer_load_dwordx4 v3, s[28:31], s57 offen lds
  s_load_dword s61, s[26:27], 0
  s_waitcnt vmcnt(16)
  s_barrier
  s_add_u32 s53, s52, 3
  s_cmp_ge_u32 s53, 9
  s_cselect_b32 s57, 9, 0
  s_sub_u32 s53, s53, s57
  s_lshl_b32 s55, s53, 7
  s_mul_i32 s56, s53, 221184
  s_add_u32 m0, s54, 114688
  s_add_u32 s58, s56, 0
  buffer_load_dwordx4 v4, s[32:35], s58 offen lds
  s_add_u32 m0, s54, 98304
  s_add_u32 s57, s55, 0
  buffer_load_dwordx4 v2, s[28:31], s57 offen lds
  s_add_u32 m0, s54, 115712
  s_add_u32 s58, s56, 13824
  buffer_load_dwordx4 v4, s[32:35], s58 offen lds
  s_add_u32 m0, s54, 99328
  s_add_u32 s57, s55, 9216
  buffer_load_dwordx4 v3, s[28:31], s57 offen lds
  s_add_u32 m0, s54, 116736
  s_add_u32 s58, s56, 27648
  buffer_load_dwordx4 v4, s[32:35], s58 offen lds
  s_add_u32 m0, s54, 100352
  s_add_u32 s57, s55, 18432
  buffer_load_dwordx4 v2, s[28:31], s57 offen lds
  s_add_u32 m0, s54, 117760
  s_add_u32 s58, s56, 41472
  buffer_load_dwordx4 v4, s[32:35], s58 offen lds
  s_add_u32 m0, s54, 101376
  s_add_u32 s57, s55, 27648
  buffer_load_dwordx4 v3, s[28:31], s57 offen lds
  s_add_u32 m0, s54, 118784
  s_add_u32 s58, s56, 55296
  buffer_load_dwordx4 v4, s[32:35], s58 offen lds
  s_add_u32 m0, s54, 102400
  s_add_u32 s57, s55, 36864
  buffer_load_dwordx4 v2, s[28:31], s57 offen lds
  s_add_u32 m0, s54, 119808
  s_add_u32 s58, s56, 69120
  buffer_load_dwordx4 v4, s[32:35], s58 offen lds
  s_add_u32 m0, s54, 103424
  s_add_u32 s57, s55, 46080
  buffer_load_dwordx4 v3, s[28:31], s57 offen lds
  s_add_u32 m0, s54, 120832
  s_add_u32 s58, s56, 82944
  buffer_load_dwordx4 v4, s[32:35], s58 offen lds
  s_add_u32 m0, s54, 104448
  s_add_u32 s57, s55, 55296
  buffer_load_dwordx4 v2, s[28:31], s57 offen lds
  s_add_u32 m0, s54, 121856
  s_add_u32 s58, s56, 96768
  buffer_load_dwordx4 v4, s[32:35], s58 offen lds
  s_add_u32 m0, s54, 105472
  s_add_u32 s57, s55, 64512
  buffer_load_dwordx4 v3, s[28:31], s57 offen lds
  s_waitcnt lgkmcnt(0)
  s_mul_i32 s61, s61, 0x9e3779b1
  s_add_u32 s51, s61, 0x7f4a7c15
  s_waitcnt vmcnt(16)
  s_barrier
  s_add_u32 s53, s52, 4
  s_cmp_ge_u32 s53, 9
  s_cselect_b32 s57, 9, 0
  s_sub_u32 s53, s53, s57
  s_lshl_b32 s55, s53, 7
  s_mul_i32 s56, s53, 221184
  s_add_u32 m0, s54, 16384
  s_add_u32 s58, s56, 0
  buffer_load_dwordx4 v4, s[32:35], s58 offen lds
  s_add_u32 m0, s54, 0
  s_add_u32 s57, s55, 0
  buffer_load_dwordx4 v2, s[28:31], s57 offen lds
  s_add_u32 m0, s54, 17408
  s_add_u32 s58, s56, 13824
  buffer_load_dwordx4 v4, s[32:35], s58 offen lds
  s_add_u32 m0, s54, 1024
  s_add_u32 s57, s55, 9216
  buffer_load_dwordx4 v3, s[28:31], s57 offen lds
  s_add_u32 m0, s54, 18432
  s_add_u32 s58, s56, 27648
  buffer_load_dwordx4 v4, s[32:35], s58 offen lds
  s_add_u32 m0, s54, 2048
  s_add_u32 s57, s55, 18432
  buffer_load_dwordx4 v2, s[28:31], s57 offen lds
  s_add_u32 m0, s54, 19456
  s_add_u32 s58, s56, 41472
  buffer_load_dwordx4 v4, s[32:35], s58 offen lds
  s_add_u32 m0, s54, 3072
  s_add_u32 s57, s55, 27648
  buffer_load_dwordx4 v3, s[28:31], s57 offen lds
  s_add_u32 m0, s54, 20480
  s_add_u32 s58, s56, 55296
  buffer_load_dwordx4 v4, s[32:35], s58 offen lds
  s_add_u32 m0, s54, 4096
  s_add_u32 s57, s55, 36864
  buffer_load_dwordx4 v2, s[28:31], s57 offen lds
  s_add_u32 m0, s54, 21504
  s_add_u32 s58, s56, 69120
  buffer_load_dwordx4 v4, s[32:35], s58 offen lds
  s_add_u32 m0, s54, 5120
  s_add_u32 s57, s55, 46080
  buffer_load_dwordx4 v3, s[28:31], s57 offen lds
  s_add_u32 m0, s54, 22528
  s_add_u32 s58, s56, 82944
  buffer_load_dwordx4 v4, s[32:35], s58 offen lds
  s_add_u32 m0, s54, 6144
  s_add_u32 s57, s55, 55296
  buffer_load_dwordx4 v2, s[28:31], s57 offen lds
  s_add_u32 m0, s54, 23552
  s_add_u32 s58, s56, 96768
  buffer_load_dwordx4 v4, s[32:35], s58 offen lds
  s_add_u32 m0, s54, 7168
  s_add_u32 s57, s55, 64512
  buffer_load_dwordx4 v3, s[28:31], s57 offen lds
  s_waitcnt vmcnt(16)
  s_barrier
  s_add_u32 s53, s52, 5
  s_cmp_ge_u32 s53, 9
  s_cselect_b32 s57, 9, 0
  s_sub_u32 s53, s53, s57
  s_lshl_b32 s55, s53, 7
  s_mul_i32 s56, s53, 221184
  s_add_u32 m0, s54, 49152
  s_add_u32 s58, s56, 0
  buffer_load_dwordx4 v4, s[32:35], s58 offen lds
  s_add_u32 m0, s54, 32768
  s_add_u32 s57, s55, 0
  buffer_load_dwordx4 v2, s[28:31], s57 offen lds
  s_add_u32 m0, s54, 50176
  s_add_u32 s58, s56, 13824
  buffer_load_dwordx4 v4, s[32:35], s58 offen lds
  s_add_u32 m0, s54, 33792
  s_add_u32 s57, s55, 9216
  buffer_load_dwordx4 v3, s[28:31], s57 offen lds
  s_add_u32 m0, s54, 51200
  s_add_u32 s58, s56, 27648
  buffer_load_dwordx4 v4, s[32:35], s58 offen lds
  s_add_u32 m0, s54, 34816
  s_add_u32 s57, s55, 18432
  buffer_load_dwordx4 v2, s[28:31], s57 offen lds
  s_add_u32 m0, s54, 52224
  s_add_u32 s58, s56, 41472
  buffer_load_dwordx4 v4, s[32:35], s58 offen lds
  s_add_u32 m0, s54, 35840
  s_add_u32 s57, s55, 27648
  buffer_load_dwordx4 v3, s[28:31], s57 offen lds
  s_add_u32 m0, s54, 53248
  s_add_u32 s58, s56, 55296
  buffer_load_dwordx4 v4, s[32:35], s58 offen lds
  s_add_u32 m0, s54, 36864
  s_add_u32 s57, s55, 36864
  buffer_load_dwordx4 v2, s[28:31], s57 offen lds
  s_add_u32 m0, s54, 54272
  s_add_u32 s58, s56, 69120
  buffer_load_dwordx4 v4, s[32:35], s58 offen lds
  s_add_u32 m0, s54, 37888
  s_add_u32 s57, s55, 46080
  buffer_load_dwordx4 v3, s[28:31], s57 offen lds
  s_add_u32 m0, s54, 55296
  s_add_u32 s58, s56, 82944
  buffer_load_dwordx4 v4, s[32:35], s58 offen lds
  s_add_u32 m0, s54, 38912
  s_add_u32 s57, s55, 55296
  buffer_load_dwordx4 v2, s[28:31], s57 offen lds
  s_add_u32 m0, s54, 56320
  s_add_u32 s58, s56, 96768
  buffer_load_dwordx4 v4, s[32:35], s58 offen lds
  s_add_u32 m0, s54, 39936
  s_add_u32 s57, s55, 64512
  buffer_load_dwordx4 v3, s[28:31], s57 offen lds
  s_waitcnt vmcnt(16)
  s_barrier
  s_add_u32 s53, s52, 6
  s_cmp_ge_u32 s53, 9
  s_cselect_b32 s57, 9, 0
  s_sub_u32 s53, s53, s57
  s_lshl_b32 s55, s53, 7
  s_mul_i32 s56, s53, 221184
  s_add_u32 m0, s54, 81920
  s_add_u32 s58, s56, 0
  buffer_load_dwordx4 v4, s[32:35], s58 offen lds
  s_add_u32 m0, s54, 65536
  s_add_u32 s57, s55, 0
  buffer_load_dwordx4 v2, s[28:31], s57 offen lds
  s_add_u32 m0, s54, 82944
  s_add_u32 s58, s56, 13824
  buffer_load_dwordx4 v4, s[32:35], s58 offen lds
  s_add_u32 m0, s54, 66560
  s_add_u32 s57, s55, 9216
  buffer_load_dwordx4 v3, s[28:31], s57 offen lds
  s_add_u32 m0, s54, 83968
  s_add_u32 s58, s56, 27648
  buffer_load_dwordx4 v4, s[32:35], s58 offen lds
  s_add_u32 m0, s54, 67584
  s_add_u32 s57, s55, 18432
  buffer_load_dwordx4 v2, s[28:31], s57 offen lds
  s_add_u32 m0, s54, 84992
  s_add_u32 s58, s56, 41472
  buffer_load_dwordx4 v4, s[32:35], s58 offen lds
  s_add_u32 m0, s54, 68608
  s_add_u32 s57, s55, 27648
  buffer_load_dwordx4 v3, s[28:31], s57 offen lds
  s_add_u32 m0, s54, 86016
  s_add_u32 s58, s56, 55296
  buffer_load_dwordx4 v4, s[32:35], s58 offen lds
  s_add_u32 m0, s54, 69632
  s_add_u32 s57, s55, 36864
  buffer_load_dwordx4 v2, s[28:31], s57 offen lds
  s_add_u32 m0, s54, 87040
  s_add_u32 s58, s56, 69120
  buffer_load_dwordx4 v4, s[32:35], s58 offen lds
  s_add_u32 m0, s54, 70656
  s_add_u32 s57, s55, 46080
  buffer_load_dwordx4 v3, s[28:31], s57 offen lds
  s_add_u32 m0, s54, 88064
  s_add_u32 s58, s56, 82944
  buffer_load_dwordx4 v4, s[32:35], s58 offen lds
  s_add_u32 m0, s54, 71680
  s_add_u32 s57, s55, 55296
  buffer_load_dwordx4 v2, s[28:31], s57 offen lds
  s_add_u32 m0, s54, 89088
  s_add_u32 s58, s56, 96768
  buffer_load_dwordx4 v4, s[32:35], s58 offen lds
  s_add_u32 m0, s54, 72704
  s_add_u32 s57, s55, 64512
  buffer_load_dwordx4 v3, s[28:31], s57 offen lds
  s_waitcnt vmcnt(16)
  s_barrier
  s_add_u32 s53, s52, 7
  s_cmp_ge_u32 s53, 9
  s_cselect_b32 s57, 9, 0
  s_sub_u32 s53, s53, s57
  s_lshl_b32 s55, s53, 7
  s_mul_i32 s56, s53, 221184
  s_add_u32 m0, s54, 114688
  s_add_u32 s58, s56, 0
  buffer_load_dwordx4 v4, s[32:35], s58 offen lds
  s_add_u32 m0, s54, 98304
  s_add_u32 s57, s55, 0
  buffer_load_dwordx4 v2, s[28:31], s57 offen lds
  s_add_u32 m0, s54, 115712
  s_add_u32 s58, s56, 13824
  buffer_load_dwordx4 v4, s[32:35], s58 offen lds
  s_add_u32 m0, s54, 99328
  s_add_u32 s57, s55, 9216
  buffer_load_dwordx4 v3, s[28:31], s57 offen lds
  s_add_u32 m0, s54, 116736
  s_add_u32 s58, s56, 27648
  buffer_load_dwordx4 v4, s[32:35], s58 offen lds
  s_add_u32 m0, s54, 100352
  s_add_u32 s57, s55, 18432
  buffer_load_dwordx4 v2, s[28:31], s57 offen lds
  s_add_u32 m0, s54, 117760
  s_add_u32 s58, s56, 41472
  buffer_load_dwordx4 v4, s[32:35], s58 offen lds
  s_add_u32 m0, s54, 101376
  s_add_u32 s57, s55, 27648
  buffer_load_dwordx4 v3, s[28:31], s57 offen lds
  s_add_u32 m0, s54, 118784
  s_add_u32 s58, s56, 55296
  buffer_load_dwordx4 v4, s[32:35], s58 offen lds
  s_add_u32 m0, s54, 102400
  s_add_u32 s57, s55, 36864
  buffer_load_dwordx4 v2, s[28:31], s57 offen lds
  s_add_u32 m0, s54, 119808
  s_add_u32 s58, s56, 69120
  buffer_load_dwordx4 v4, s[32:35], s58 offen lds
  s_add_u32 m0, s54, 103424
  s_add_u32 s57, s55, 46080
  buffer_load_dwordx4 v3, s[28:31], s57 offen lds
  s_add_u32 m0, s54, 120832
  s_add_u32 s58, s56, 82944
  buffer_load_dwordx4 v4, s[32:35], s58 offen lds
  s_add_u32 m0, s54, 104448
  s_add_u32 s57, s55, 55296
  buffer_load_dwordx4 v2, s[28:31], s57 offen lds
  s_add_u32 m0, s54, 121856
  s_add_u32 s58, s56, 96768
  buffer_load_dwordx4 v4, s[32:35], s58 offen lds
  s_add_u32 m0, s54, 105472
  s_add_u32 s57, s55, 64512
  buffer_load_dwordx4 v3, s[28:31], s57 offen lds
  s_waitcnt vmcnt(16)
  s_barrier
  s_waitcnt vmcnt(0)
  v_mov_b32 v90, 158252
  v_mov_b32 v91, 1
  s_mov_b64 exec, 1
  ds_add_u32 v90, v91
  s_mov_b64 exec, -1
  s_add_u32 s53, s52, 8
  s_cmp_ge_u32 s53, 9
  s_cselect_b32 s57, 9, 0
  s_sub_u32 s53, s53, s57
  s_lshl_b32 s55, s53, 7
  s_mul_i32 s56, s53, 221184
  s_add_u32 m0, s54, 16384
  s_add_u32 s58, s56, 0
  buffer_load_dwordx4 v4, s[32:35], s58 offen lds
  s_add_u32 m0, s54, 0
  s_add_u32 s57, s55, 0
  buffer_load_dwordx4 v2, s[28:31], s57 offen lds
  s_add_u32 m0, s54, 17408
  s_add_u32 s58, s56, 13824
  buffer_load_dwordx4 v4, s[32:35], s58 offen lds
  s_add_u32 m0, s54, 1024
  s_add_u32 s57, s55, 9216
  buffer_load_dwordx4 v3, s[28:31], s57 offen lds
  s_add_u32 m0, s54, 18432
  s_add_u32 s58, s56, 27648
  buffer_load_dwordx4 v4, s[32:35], s58 offen lds
  s_add_u32 m0, s54, 2048
  s_add_u32 s57, s55, 18432
  buffer_load_dwordx4 v2, s[28:31], s57 offen lds
  s_add_u32 m0, s54, 19456
  s_add_u32 s58, s56, 41472
  buffer_load_dwordx4 v4, s[32:35], s58 offen lds
  s_add_u32 m0, s54, 3072
  s_add_u32 s57, s55, 27648
  buffer_load_dwordx4 v3, s[28:31], s57 offen lds
  s_add_u32 m0, s54, 20480
  s_add_u32 s58, s56, 55296
  buffer_load_dwordx4 v4, s[32:35], s58 offen lds
  s_add_u32 m0, s54, 4096
  s_add_u32 s57, s55, 36864
  buffer_load_dwordx4 v2, s[28:31], s57 offen lds
  s_add_u32 m0, s54, 21504
  s_add_u32 s58, s56, 69120
  buffer_load_dwordx4 v4, s[32:35], s58 offen lds
  s_add_u32 m0, s54, 5120
  s_add_u32 s57, s55, 46080
  buffer_load_dwordx4 v3, s[28:31], s57 offen lds
  s_add_u32 m0, s54, 22528
  s_add_u32 s58, s56, 82944
  buffer_load_dwordx4 v4, s[32:35], s58 offen lds
  s_add_u32 m0, s54, 6144
  s_add_u32 s57, s55, 55296
  buffer_load_dwordx4 v2, s[28:31], s57 offen lds
  s_add_u32 m0, s54, 23552
  s_add_u32 s58, s56, 96768
  buffer_load_dwordx4 v4, s[32:35], s58 offen lds
  s_add_u32 m0, s54, 7168
  s_add_u32 s57, s55, 64512
  buffer_load_dwordx4 v3, s[28:31], s57 offen lds
  v_mov_b32 v90, 158260
  v_mov_b32 v91, 1
  s_mov_b64 exec, 1
  ds_add_u32 v90, v91
  s_mov_b64 exec, -1
  s_waitcnt vmcnt(0)
  v_mov_b32 v90, 158256
  v_mov_b32 v91, 1
  s_mov_b64 exec, 1
  ds_add_u32 v90, v91
  s_mov_b64 exec, -1
  s_and_b32 s62, s60, 7
  s_lshr_b32 s63, s60, 3
  s_and_b32 s44, s62, 3
  s_lshl_b32 s44, s44, 3
  s_and_b32 s46, s63, 7
  s_add_u32 s44, s44, s46
  s_lshr_b32 s45, s62, 2
  s_lshl_b32 s45, s45, 2
  s_lshr_b32 s46, s63, 3
  s_add_u32 s45, s45, s46
  v_mov_b32 v90, 158232
  s_mov_b64 exec, 1
  s_mov_b32 s59, 0
Lls_60:
  ds_read_b32 v91, v90
  s_add_u32 s59, s59, 1
  s_cmp_ge_u32 s59, 4000000
  s_waitcnt lgkmcnt(0)
  v_readfirstlane_b32 s63, v91
  s_cbranch_scc1 Llsd_61
  s_cmp_lt_u32 s63, 4
  s_cbranch_scc1 Lls_60
Llsd_61:
  s_mov_b64 exec, -1
  s_lshl_b32 s62, s45, 7
  s_add_u32 s62, s62, 49152
  v_min_u32 v76, 17, v1
  v_lshlrev_b32 v76, 2, v76
  v_add_u32 v76, s62, v76
  v_mov_b32 v86, s51
  v_not_b32 v86, v86
  s_mov_b32 s59, 0
Lpoll_62:
  v_cmp_ne_u32 vcc, s51, v86
  s_nop 0
  s_cbranch_vccz Lpolld_63
  buffer_load_dword v86, v76, s[36:39], 0 offen sc1
  s_add_u32 s59, s59, 1
  s_cmp_lt_u32 s59, 200000
  s_waitcnt vmcnt(0)
  s_cbranch_scc1 Lpoll_62
Lpolld_63:
  v_lshlrev_b32 v5, 4, v1
  s_mul_i32 s56, s45, 82944
  s_lshl_b32 s55, s47, 10
  s_add_u32 s56, s56, s55
  s_add_u32 s56, s56, 4194304
  s_add_u32 m0, s55, 0
  s_add_u32 s57, s56, 0
  buffer_load_dwordx4 v5, s[36:39], s57 offen sc1 lds
  s_add_u32 m0, s55, 2048
  s_add_u32 s57, s56, 2048
  buffer_load_dwordx4 v5, s[36:39], s57 offen sc1 lds
  s_add_u32 m0, s55, 4096
  s_add_u32 s57, s56, 4096
  buffer_load_dwordx4 v5, s[36:39], s57 offen sc1 lds
  s_add_u32 m0, s55, 6144
  s_add_u32 s57, s56, 6144
  buffer_load_dwordx4 v5, s[36:39], s57 offen sc1 lds
  s_add_u32 m0, s55, 8192
  s_add_u32 s57, s56, 8192
  buffer_load_dwordx4 v5, s[36:39], s57 offen sc1 lds
  s_add_u32 m0, s55, 10240
  s_add_u32 s57, s56, 10240
  buffer_load_dwordx4 v5, s[36:39], s57 offen sc1 lds
  s_add_u32 m0, s55, 12288
  s_add_u32 s57, s56, 12288
  buffer_load_dwordx4 v5, s[36:39], s57 offen sc1 lds
  s_add_u32 m0, s55, 14336
  s_add_u32 s57, s56, 14336
  buffer_load_dwordx4 v5, s[36:39], s57 offen sc1 lds
  s_add_u32 m0, s55, 16384
  s_add_u32 s57, s56, 16384
  buffer_load_dwordx4 v5, s[36:39], s57 offen sc1 lds
  s_add_u32 m0, s55, 18432
  s_add_u32 s57, s56, 18432
  buffer_load_dwordx4 v5, s[36:39], s57 offen sc1 lds
  s_add_u32 m0, s55, 20480
  s_add_u32 s57, s56, 20480
  buffer_load_dwordx4 v5, s[36:39], s57 offen sc1 lds
  s_add_u32 m0, s55, 22528
  s_add_u32 s57, s56, 22528
  buffer_load_dwordx4 v5, s[36:39], s57 offen sc1 lds
  s_add_u32 m0, s55, 24576
  s_add_u32 s57, s56, 24576
  buffer_load_dwordx4 v5, s[36:39], s57 offen sc1 lds
  s_add_u32 m0, s55, 26624
  s_add_u32 s57, s56, 26624
  buffer_load_dwordx4 v5, s[36:39], s57 offen sc1 lds
  s_add_u32 m0, s55, 28672
  s_add_u32 s57, s56, 28672
  buffer_load_dwordx4 v5, s[36:39], s57 offen sc1 lds
  s_add_u32 m0, s55, 30720
  s_add_u32 s57, s56, 30720
  buffer_load_dwordx4 v5, s[36:39], s57 offen sc1 lds
  s_add_u32 m0, s55, 32768
  s_add_u32 s57, s56, 32768
  buffer_load_dwordx4 v5, s[36:39], s57 offen sc1 lds
  s_add_u32 m0, s55, 34816
  s_add_u32 s57, s56, 34816
  buffer_load_dwordx4 v5, s[36:39], s57 offen sc1 lds
  s_add_u32 m0, s55, 36864
  s_add_u32 s57, s56, 36864
  buffer_load_dwordx4 v5, s[36:39], s57 offen sc1 lds
  s_add_u32 m0, s55, 38912
  s_add_u32 s57, s56, 38912
  buffer_load_dwordx4 v5, s[36:39], s57 offen sc1 lds
  s_add_u32 m0, s55, 40960
  s_add_u32 s57, s56, 40960
  buffer_load_dwordx4 v5, s[36:39], s57 offen sc1 lds
  s_add_u32 m0, s55, 43008
  s_add_u32 s57, s56, 43008
  buffer_load_dwordx4 v5, s[36:39], s57 offen sc1 lds
  s_add_u32 m0, s55, 45056
  s_add_u32 s57, s56, 45056
  buffer_load_dwordx4 v5, s[36:39], s57 offen sc1 lds
  s_add_u32 m0, s55, 47104
  s_add_u32 s57, s56, 47104
  buffer_load_dwordx4 v5, s[36:39], s57 offen sc1 lds
  s_add_u32 m0, s55, 49152
  s_add_u32 s57, s56, 49152
  buffer_load_dwordx4 v5, s[36:39], s57 offen sc1 lds
  s_add_u32 m0, s55, 51200
  s_add_u32 s57, s56, 51200
  buffer_load_dwordx4 v5, s[36:39], s57 offen sc1 lds
  s_add_u32 m0, s55, 53248
  s_add_u32 s57, s56, 53248
  buffer_load_dwordx4 v5, s[36:39], s57 offen sc1 lds
  s_add_u32 m0, s55, 55296
  s_add_u32 s57, s56, 55296
  buffer_load_dwordx4 v5, s[36:39], s57 offen sc1 lds
  s_add_u32 m0, s55, 57344
  s_add_u32 s57, s56, 57344
  buffer_load_dwordx4 v5, s[36:39], s57 offen sc1 lds
  s_add_u32 m0, s55, 59392
  s_add_u32 s57, s56, 59392
  buffer_load_dwordx4 v5, s[36:39], s57 offen sc1 lds
  s_add_u32 m0, s55, 61440
  s_add_u32 s57, s56, 61440
  buffer_load_dwordx4 v5, s[36:39], s57 offen sc1 lds
  s_add_u32 m0, s55, 63488
  s_add_u32 s57, s56, 63488
  buffer_load_dwordx4 v5, s[36:39], s57 offen sc1 lds
  s_add_u32 m0, s55, 65536
  s_add_u32 s57, s56, 65536
  buffer_load_dwordx4 v5, s[36:39], s57 offen sc1 lds
  s_add_u32 m0, s55, 67584
  s_add_u32 s57, s56, 67584
  buffer_load_dwordx4 v5, s[36:39], s57 offen sc1 lds
  s_add_u32 m0, s55, 69632
  s_add_u32 s57, s56, 69632
  buffer_load_dwordx4 v5, s[36:39], s57 offen sc1 lds
  s_add_u32 m0, s55, 71680
  s_add_u32 s57, s56, 71680
  buffer_load_dwordx4 v5, s[36:39], s57 offen sc1 lds
  s_add_u32 m0, s55, 73728
  s_add_u32 s57, s56, 73728
  buffer_load_dwordx4 v5, s[36:39], s57 offen sc1 lds
  s_add_u32 m0, s55, 75776
  s_add_u32 s57, s56, 75776
  buffer_load_dwordx4 v5, s[36:39], s57 offen sc1 lds
  s_add_u32 m0, s55, 77824
  s_add_u32 s57, s56, 77824
  buffer_load_dwordx4 v5, s[36:39], s57 offen sc1 lds
  s_add_u32 m0, s55, 79872
  s_add_u32 s57, s56, 79872
  buffer_load_dwordx4 v5, s[36:39], s57 offen sc1 lds
  s_add_u32 m0, s55, 81920
  s_add_u32 s57, s56, 81920
  s_cmp_eq_u32 s47, 0
  s_cselect_b32 s57, s57, 0x7fff0000
  s_cselect_b32 s58, 0, 1
  s_mul_i32 s58, s58, 70144
  s_add_u32 m0, s58, 81920
  s_nop 0
  buffer_load_dwordx4 v5, s[36:39], s57 offen sc1 lds
  v_and_b32 v9, 15, v1
  v_lshrrev_b32 v10, 4, v1
  v_mul_u32_u24 v8, 3072, v10
  v_lshl_add_u32 v8, v9, 4, v8
  v_and_b32 v11, 1, v9
  v_cmp_eq_u32 vcc, 1, v11
  v_mov_b32 v11, 0x3f80
  v_mov_b32 v22, 0x3f800000
  v_cndmask_b32 v11, v11, v22, vcc
  v_lshrrev_b32 v22, 1, v9
  v_cmp_eq_u32 vcc, 0, v22
  s_nop 1
  v_cndmask_b32 v12, 0, v11, vcc
  v_cmp_eq_u32 vcc, 1, v22
  s_nop 1
  v_cndmask_b32 v13, 0, v11, vcc
  v_cmp_eq_u32 vcc, 2, v22
  s_nop 1
  v_cndmask_b32 v14, 0, v11, vcc
  v_cmp_eq_u32 vcc, 3, v22
  s_nop 1
  v_cndmask_b32 v15, 0, v11, vcc
  s_mul_i32 s62, s47, 1600
  s_add_u32 s62, s62, 137728
  v_mov_b32 v23, 141568
  v_cmp_gt_u32 s[2:3], 2, v10
  v_mul_u32_u24 v24, 80, v9
  v_lshl_add_u32 v24, v10, 5, v24
  v_add_u32 v24, s62, v24
  v_add_u32 v25, 0, v24
  v_cndmask_b32 v16, v23, v25, s[2:3]
  v_add_u32 v25, 8, v24
  v_cndmask_b32 v17, v23, v25, s[2:3]
  v_add_u32 v25, 16, v24
  v_cndmask_b32 v18, v23, v25, s[2:3]
  v_add_u32 v25, 24, v24
  v_cndmask_b32 v19, v23, v25, s[2:3]
  v_lshl_add_u32 v25, v9, 1, v10
  v_mul_u32_u24 v25, 80, v25
  v_add_u32 v25, 64, v25
  v_add_u32 v26, -8, v9
  v_and_b32 v27, 3, v26
  v_add_u32 v27, 16, v27
  v_mul_u32_u24 v27, 80, v27
  v_lshrrev_b32 v26, 2, v26
  v_lshl_add_u32 v27, v26, 3, v27
  v_lshl_add_u32 v27, v10, 5, v27
  v_cmp_gt_u32 vcc, 8, v9
  s_nop 1
  v_cndmask_b32 v27, v27, v25, vcc
  v_add_u32 v27, s62, v27
  v_cndmask_b32 v20, v23, v27, s[2:3]
  v_add_u32 v26, 8, v9
  v_and_b32 v27, 3, v26
  v_add_u32 v27, 16, v27
  v_mul_u32_u24 v27, 80, v27
  v_lshrrev_b32 v26, 2, v26
  v_lshl_add_u32 v27, v26, 3, v27
  v_lshl_add_u32 v27, v10, 5, v27
  v_subrev_u32 v26, 8, v9
  v_lshl_add_u32 v26, v26, 1, v10
  v_add_u32 v26, 16, v26
  v_mul_u32_u24 v26, 80, v26
  v_add_u32 v26, 64, v26
  v_cmp_gt_u32 vcc, 8, v9
  s_nop 1
  v_cndmask_b32 v27, v26, v27, vcc
  v_add_u32 v27, s62, v27
  v_cmp_gt_u32 vcc, 10, v9
  s_nop 0
  s_and_b64 vcc, vcc, s[2:3]
  v_cndmask_b32 v21, v23, v27, vcc
  s_lshl_b32 s62, s50, 7
  s_add_u32 s62, s62, 45056
  v_and_b32 v76, 15, v1
  v_lshlrev_b32 v76, 2, v76
  v_add_u32 v76, s62, v76
  v_mov_b32 v77, s51
  v_not_b32 v77, v77
  s_mul_i32 s46, s50, 49152
  s_mul_i32 s63, s47, 1536
  s_add_u32 s46, s46, s63
  s_add_u32 s46, s46, 65536
  s_cmp_eq_u32 s47, 0
  s_cbranch_scc0 Lp1_64
  s_mov_b32 s59, 0
Lpoll_66:
  v_cmp_ne_u32 vcc, s51, v77
  s_nop 0
  s_cbranch_vccz Lpolld_67
  buffer_load_dword v77, v76, s[36:39], 0 offen sc1
  s_add_u32 s59, s59, 1
  s_cmp_lt_u32 s59, 200000
  s_waitcnt vmcnt(0)
  s_cbranch_scc1 Lpoll_66
Lpolld_67:
  v_mov_b32 v90, 158268
  v_mov_b32 v91, 1
  s_mov_b64 exec, 1
  ds_add_u32 v90, v91
  s_mov_b64 exec, -1
  s_branch Lpj_65
Lp1_64:
  s_waitcnt vmcnt(0)
  v_mov_b32 v90, 158268
  s_mov_b64 exec, 1
  s_mov_b32 s59, 0
Lls_68:
  ds_read_b32 v91, v90
  s_add_u32 s59, s59, 1
  s_cmp_ge_u32 s59, 4000000
  s_waitcnt lgkmcnt(0)
  v_readfirstlane_b32 s63, v91
  s_cbranch_scc1 Llsd_69
  s_cmp_lt_u32 s63, 1
  s_cbranch_scc1 Lls_68
Llsd_69:
  s_mov_b64 exec, -1
Lpj_65:
  s_add_u32 s63, s46, 0
  s_nop 1
  buffer_load_dwordx4 v[96:99], v8, s[36:39], s63 offen sc1
  s_add_u32 s63, s46, 12288
  buffer_load_dwordx4 v[100:103], v8, s[36:39], s63 offen sc1
  s_add_u32 s63, s46, 24576
  buffer_load_dwordx4 v[104:107], v8, s[36:39], s63 offen sc1
  s_add_u32 s63, s46, 36864
  buffer_load_dwordx4 v[108:111], v8, s[36:39], s63 offen sc1
  s_add_u32 s63, s46, 256
  buffer_load_dwordx4 v[112:115], v8, s[36:39], s63 offen sc1
  s_add_u32 s63, s46, 12544
  buffer_load_dwordx4 v[116:119], v8, s[36:39], s63 offen sc1
  s_add_u32 s63, s46, 24832
  buffer_load_dwordx4 v[120:123], v8, s[36:39], s63 offen sc1
  s_add_u32 s63, s46, 37120
  buffer_load_dwordx4 v[124:127], v8, s[36:39], s63 offen sc1
  s_add_u32 s63, s46, 512
  buffer_load_dwordx4 v[128:131], v8, s[36:39], s63 offen sc1
  s_add_u32 s63, s46, 12800
  buffer_load_dwordx4 v[132:135], v8, s[36:39], s63 offen sc1
  s_add_u32 s63, s46, 25088
  buffer_load_dwordx4 v[136:139], v8, s[36:39], s63 offen sc1
  s_add_u32 s63, s46, 37376
  buffer_load_dwordx4 v[140:143], v8, s[36:39], s63 offen sc1
  s_add_u32 s63, s46, 768
  buffer_load_dwordx4 v[144:147], v8, s[36:39], s63 offen sc1
  s_add_u32 s63, s46, 13056
  buffer_load_dwordx4 v[148:151], v8, s[36:39], s63 offen sc1
  s_add_u32 s63, s46, 25344
  buffer_load_dwordx4 v[152:155], v8, s[36:39], s63 offen sc1
  s_add_u32 s63, s46, 37632
  buffer_load_dwordx4 v[156:159], v8, s[36:39], s63 offen sc1
  s_add_u32 s63, s46, 1024
  buffer_load_dwordx4 v[160:163], v8, s[36:39], s63 offen sc1
  s_add_u32 s63, s46, 13312
  buffer_load_dwordx4 v[164:167], v8, s[36:39], s63 offen sc1
  s_add_u32 s63, s46, 25600
  buffer_load_dwordx4 v[168:171], v8, s[36:39], s63 offen sc1
  s_add_u32 s63, s46, 37888
  buffer_load_dwordx4 v[172:175], v8, s[36:39], s63 offen sc1
  s_add_u32 s63, s46, 1280
  buffer_load_dwordx4 v[176:179], v8, s[36:39], s63 offen sc1
  s_add_u32 s63, s46, 13568
  buffer_load_dwordx4 v[180:183], v8, s[36:39], s63 offen sc1
  s_add_u32 s63, s46, 25856
  buffer_load_dwordx4 v[184:187], v8, s[36:39], s63 offen sc1
  s_add_u32 s63, s46, 38144
  buffer_load_dwordx4 v[188:191], v8, s[36:39], s63 offen sc1
  s_waitcnt vmcnt(23)
  v_mfma_f32_16x16x32_bf16 v[64:67], v[12:15], v[96:99], 0
  s_waitcnt vmcnt(22)
  v_mfma_f32_16x16x32_bf16 v[64:67], v[12:15], v[100:103], v[64:67]
  s_waitcnt vmcnt(21)
  v_mfma_f32_16x16x32_bf16 v[64:67], v[12:15], v[104:107], v[64:67]
  s_waitcnt vmcnt(20)
  v_mfma_f32_16x16x32_bf16 v[64:67], v[12:15], v[108:111], v[64:67]
  s_waitcnt vmcnt(19)
  v_mfma_f32_16x16x32_bf16 v[68:71], v[12:15], v[112:115], 0
  s_waitcnt vmcnt(18)
  v_mfma_f32_16x16x32_bf16 v[68:71], v[12:15], v[116:119], v[68:71]
  s_waitcnt vmcnt(17)
  v_mfma_f32_16x16x32_bf16 v[68:71], v[12:15], v[120:123], v[68:71]
  s_waitcnt vmcnt(16)
  v_mfma_f32_16x16x32_bf16 v[68:71], v[12:15], v[124:127], v[68:71]
  v_cvt_pk_bf16_f32 v64, v64, v65
  v_cvt_pk_bf16_f32 v65, v66, v67
  ds_write_b64 v16, v[64:65]
  s_waitcnt vmcnt(15)
  v_mfma_f32_16x16x32_bf16 v[72:75], v[12:15], v[128:131], 0
  s_waitcnt vmcnt(14)
  v_mfma_f32_16x16x32_bf16 v[72:75], v[12:15], v[132:135], v[72:75]
  s_waitcnt vmcnt(13)
  v_mfma_f32_16x16x32_bf16 v[72:75], v[12:15], v[136:139], v[72:75]
  s_waitcnt vmcnt(12)
  v_mfma_f32_16x16x32_bf16 v[72:75], v[12:15], v[140:143], v[72:75]
  v_cvt_pk_bf16_f32 v68, v68, v69
  v_cvt_pk_bf16_f32 v69, v70, v71
  ds_write_b64 v17, v[68:69]
  s_waitcnt vmcnt(11)
  v_mfma_f32_16x16x32_bf16 v[76:79], v[12:15], v[144:147], 0
  s_waitcnt vmcnt(10)
  v_mfma_f32_16x16x32_bf16 v[76:79], v[12:15], v[148:151], v[76:79]
  s_waitcnt vmcnt(9)
  v_mfma_f32_16x16x32_bf16 v[76:79], v[12:15], v[152:155], v[76:79]
  s_waitcnt vmcnt(8)
  v_mfma_f32_16x16x32_bf16 v[76:79], v[12:15], v[156:159], v[76:79]
  v_cvt_pk_bf16_f32 v72, v72, v73
  v_cvt_pk_bf16_f32 v73, v74, v75
  ds_write_b64 v18, v[72:73]
  s_waitcnt vmcnt(7)
  v_mfma_f32_16x16x32_bf16 v[80:83], v[12:15], v[160:163], 0
  s_waitcnt vmcnt(6)
  v_mfma_f32_16x16x32_bf16 v[80:83], v[12:15], v[164:167], v[80:83]
  s_waitcnt vmcnt(5)
  v_mfma_f32_16x16x32_bf16 v[80:83], v[12:15], v[168:171], v[80:83]
  s_waitcnt vmcnt(4)
  v_mfma_f32_16x16x32_bf16 v[80:83], v[12:15], v[172:175], v[80:83]
  v_cvt_pk_bf16_f32 v76, v76, v77
  v_cvt_pk_bf16_f32 v77, v78, v79
  ds_write_b64 v19, v[76:77]
  s_waitcnt vmcnt(3)
  v_mfma_f32_16x16x32_bf16 v[84:87], v[12:15], v[176:179], 0
  s_waitcnt vmcnt(2)
  v_mfma_f32_16x16x32_bf16 v[84:87], v[12:15], v[180:183], v[84:87]
  s_waitcnt vmcnt(1)
  v_mfma_f32_16x16x32_bf16 v[84:87], v[12:15], v[184:187], v[84:87]
  s_waitcnt vmcnt(0)
  v_mfma_f32_16x16x32_bf16 v[84:87], v[12:15], v[188:191], v[84:87]
  v_cvt_pk_bf16_f32 v80, v80, v81
  v_cvt_pk_bf16_f32 v81, v82, v83
  ds_write_b64 v20, v[80:81]
  s_nop 4
  v_cvt_pk_bf16_f32 v84, v84, v85
  v_cvt_pk_bf16_f32 v85, v86, v87
  ds_write_b64 v21, v[84:85]
  s_waitcnt lgkmcnt(0)
  v_mov_b32 v90, 158224
  v_mov_b32 v91, 1
  s_mov_b64 exec, 1
  ds_add_u32 v90, v91
  s_mov_b64 exec, -1
  s_lshr_b32 s62, s44, 1
  s_lshl_b32 s62, s62, 7
  s_add_u32 s62, s62, 47104
  v_and_b32 v76, 15, v1
  v_lshlrev_b32 v76, 2, v76
  v_add_u32 v76, s62, v76
  v_mov_b32 v77, s51
  v_not_b32 v77, v77
  s_cmp_eq_u32 s47, 0
  s_cbranch_scc0 Lq1_70
  s_mov_b32 s59, 0
Lpoll_71:
  v_cmp_ne_u32 vcc, s51, v77
  s_nop 0
  s_cbranch_vccz Lpolld_72
  buffer_load_dword v77, v76, s[36:39], 0 offen sc1
  s_add_u32 s59, s59, 1
  s_cmp_lt_u32 s59, 200000
  s_waitcnt vmcnt(0)
  s_cbranch_scc1 Lpoll_71
Lpolld_72:
Lq1_70:
  s_waitcnt vmcnt(0)
  v_mov_b32 v90, 158228
  v_mov_b32 v91, 1
  s_mov_b64 exec, 1
  ds_add_u32 v90, v91
  s_mov_b64 exec, -1
  s_waitcnt vmcnt(0) lgkmcnt(0)
  s_endpgm
L_moe:
  s_waitcnt lgkmcnt(0)
  s_mov_b32 s28, s4
  s_mov_b32 s29, s5
  s_mov_b32 s30, 2359296
  s_mov_b32 s31, 0x00020000
  s_mov_b32 s36, s26
  s_mov_b32 s37, s27
  s_mov_b32 s38, 33554432
  s_mov_b32 s39, 0x00020000
  s_sub_u32 s25, s47, 2
  s_mul_hi_u32 s24, s60, 59652324
  s_mul_i32 s62, s24, 72
  s_sub_u32 s13, s60, s62
  v_and_b32 v9, 15, v1
  v_lshrrev_b32 v10, 4, v1
  v_lshrrev_b32 v24, 3, v9
  v_lshl_add_u32 v24, v10, 1, v24
  v_mul_u32_u24 v25, 9216, v24
  v_and_b32 v26, 7, v9
  v_lshl_add_u32 v25, v26, 4, v25
  s_mul_i32 s62, s24, 192
  s_mul_i32 s63, s25, 96
  s_add_u32 s62, s62, s63
  s_mul_i32 s62, s62, 9216
  s_lshl_b32 s63, s13, 7
  s_add_u32 s56, s62, s63
  s_cmp_lt_u32 s60, 216
  s_cselect_b32 s56, s56, 0x7fff0000
  v_and_b32 v26, 1, v9
  v_cmp_eq_u32 vcc, 1, v26
  v_mov_b32 v26, 0xffff
  v_mov_b32 v27, 0xffff0000
  v_cndmask_b32 v26, v26, v27, vcc
  v_bfe_u32 v27, v9, 1, 2
  v_cmp_gt_u32 s[2:3], 8, v9
  v_cmp_eq_u32 vcc, 0, v27
  s_nop 1
  v_cndmask_b32 v16, 0, v26, vcc
  v_cndmask_b32 v20, 0, v16, s[2:3]
  v_cmp_eq_u32 vcc, 1, v27
  s_nop 1
  v_cndmask_b32 v17, 0, v26, vcc
  v_cndmask_b32 v21, 0, v17, s[2:3]
  v_cmp_eq_u32 vcc, 2, v27
  s_nop 1
  v_cndmask_b32 v18, 0, v26, vcc
  v_cndmask_b32 v22, 0, v18, s[2:3]
  v_cmp_eq_u32 vcc, 3, v27
  s_nop 1
  v_cndmask_b32 v19, 0, v26, vcc
  v_cndmask_b32 v23, 0, v19, s[2:3]
  v_and_b32 v26, 1, v9
  v_cmp_eq_u32 vcc, 1, v26
  v_mov_b32 v26, 0x3f80
  v_mov_b32 v27, 0x3f800000
  v_cndmask_b32 v26, v26, v27, vcc
  v_lshrrev_b32 v27, 1, v9
  v_cmp_eq_u32 vcc, 0, v27
  s_nop 1
  v_cndmask_b32 v12, 0, v26, vcc
  v_cmp_eq_u32 vcc, 1, v27
  s_nop 1
  v_cndmask_b32 v13, 0, v26, vcc
  v_cmp_eq_u32 vcc, 2, v27
  s_nop 1
  v_cndmask_b32 v14, 0, v26, vcc
  v_cmp_eq_u32 vcc, 3, v27
  s_nop 1
  v_cndmask_b32 v15, 0, v26, vcc
  s_load_dword s61, s[26:27], 0
  s_cmp_eq_u32 s25, 0
  s_cbranch_scc0 Lm3_73
  s_barrier
  s_barrier
  s_barrier
  s_waitcnt lgkmcnt(0)
  s_mul_i32 s61, s61, 0x9e3779b1
  s_add_u32 s51, s61, 0x7f4a7c15
  s_and_b32 s62, s60, 7
  s_lshr_b32 s63, s60, 3
  s_and_b32 s44, s62, 3
  s_lshl_b32 s44, s44, 3
  s_and_b32 s46, s63, 7
  s_add_u32 s44, s44, s46
  s_lshr_b32 s45, s62, 2
  s_lshl_b32 s45, s45, 2
  s_lshr_b32 s46, s63, 3
  s_add_u32 s45, s45, s46
  s_barrier
  s_barrier
  v_lshlrev_b32 v93, 4, v1
  v_add_u32 v93, 36864, v93
  s_mov_b32 s63, 0
  buffer_load_dwordx4 v[96:99], v93, s[36:39], s63 offen sc1
  s_mov_b32 s63, 1024
  buffer_load_dwordx4 v[100:103], v93, s[36:39], s63 offen sc1
  s_mov_b32 s63, 2048
  buffer_load_dwordx4 v[104:107], v93, s[36:39], s63 offen sc1
  s_mov_b32 s63, 3072
  buffer_load_dwordx4 v[108:111], v93, s[36:39], s63 offen sc1
  s_mov_b32 s63, 4096
  buffer_load_dwordx4 v[112:115], v93, s[36:39], s63 offen sc1
  s_mov_b32 s63, 5120
  buffer_load_dwordx4 v[116:119], v93, s[36:39], s63 offen sc1
  s_mov_b32 s63, 6144
  buffer_load_dwordx4 v[120:123], v93, s[36:39], s63 offen sc1
  s_mov_b32 s63, 7168
  buffer_load_dwordx4 v[124:127], v93, s[36:39], s63 offen sc1
  s_barrier
  s_waitcnt vmcnt(0)
  s_mov_b32 s59, 0
Lrp_76:
  v_mov_b32 v95, s51
  v_mov_b32 v94, 0
  v_bitop3_b32 v94, v97, v95, v94 bitop3:0xbe
  v_bitop3_b32 v94, v99, v95, v94 bitop3:0xbe
  v_bitop3_b32 v94, v101, v95, v94 bitop3:0xbe
  v_bitop3_b32 v94, v103, v95, v94 bitop3:0xbe
  v_bitop3_b32 v94, v105, v95, v94 bitop3:0xbe
  v_bitop3_b32 v94, v107, v95, v94 bitop3:0xbe
  v_bitop3_b32 v94, v109, v95, v94 bitop3:0xbe
  v_bitop3_b32 v94, v111, v95, v94 bitop3:0xbe
  v_bitop3_b32 v94, v113, v95, v94 bitop3:0xbe
  v_bitop3_b32 v94, v115, v95, v94 bitop3:0xbe
  v_bitop3_b32 v94, v117, v95, v94 bitop3:0xbe
  v_bitop3_b32 v94, v119, v95, v94 bitop3:0xbe
  v_bitop3_b32 v94, v121, v95, v94 bitop3:0xbe
  v_bitop3_b32 v94, v123, v95, v94 bitop3:0xbe
  v_bitop3_b32 v94, v125, v95, v94 bitop3:0xbe
  v_bitop3_b32 v94, v127, v95, v94 bitop3:0xbe
  v_and_b32 v94, 0xfffffffe, v94
  v_cmp_ne_u32 vcc, 0, v94
  s_nop 0
  s_cbranch_vccz Lrd_77
  s_mov_b32 s63, 0
  buffer_load_dwordx4 v[96:99], v93, s[36:39], s63 offen sc1
  s_mov_b32 s63, 1024
  buffer_load_dwordx4 v[100:103], v93, s[36:39], s63 offen sc1
  s_mov_b32 s63, 2048
  buffer_load_dwordx4 v[104:107], v93, s[36:39], s63 offen sc1
  s_mov_b32 s63, 3072
  buffer_load_dwordx4 v[108:111], v93, s[36:39], s63 offen sc1
  s_mov_b32 s63, 4096
  buffer_load_dwordx4 v[112:115], v93, s[36:39], s63 offen sc1
  s_mov_b32 s63, 5120
  buffer_load_dwordx4 v[116:119], v93, s[36:39], s63 offen sc1
  s_mov_b32 s63, 6144
  buffer_load_dwordx4 v[120:123], v93, s[36:39], s63 offen sc1
  s_mov_b32 s63, 7168
  buffer_load_dwordx4 v[124:127], v93, s[36:39], s63 offen sc1
  s_add_u32 s59, s59, 1
  s_cmp_lt_u32 s59, 200000
  s_waitcnt vmcnt(0)
  s_cbranch_scc1 Lrp_76
Lrd_77:
  v_mov_b32 v95, 0
  v_lshlrev_b32 v94, 2, v1
  s_barrier
  v_mov_b32 v92, 0x80000000
  v_mov_b32 v87, 0x7ff
  v_ashrrev_i32 v88, 31, v96
  v_and_or_b32 v89, v97, 1, v94
  v_bitop3_b32 v88, v96, v88, v92 bitop3:0x1e
  v_sub_u32 v89, 2047, v89
  v_bfi_b32 v88, v87, v89, v88
  v_max_u32 v95, v95, v88
  v_ashrrev_i32 v88, 31, v98
  v_and_or_b32 v89, v99, 1, v94
  v_bitop3_b32 v88, v98, v88, v92 bitop3:0x1e
  v_sub_u32 v89, 2045, v89
  v_bfi_b32 v88, v87, v89, v88
  v_max_u32 v95, v95, v88
  v_ashrrev_i32 v88, 31, v100
  v_and_or_b32 v89, v101, 1, v94
  v_bitop3_b32 v88, v100, v88, v92 bitop3:0x1e
  v_sub_u32 v89, 1791, v89
  v_bfi_b32 v88, v87, v89, v88
  v_max_u32 v95, v95, v88
  v_ashrrev_i32 v88, 31, v102
  v_and_or_b32 v89, v103, 1, v94
  v_bitop3_b32 v88, v102, v88, v92 bitop3:0x1e
  v_sub_u32 v89, 1789, v89
  v_bfi_b32 v88, v87, v89, v88
  v_max_u32 v95, v95, v88
  v_ashrrev_i32 v88, 31, v104
  v_and_or_b32 v89, v105, 1, v94
  v_bitop3_b32 v88, v104, v88, v92 bitop3:0x1e
  v_sub_u32 v89, 1535, v89
  v_bfi_b32 v88, v87, v89, v88
  v_max_u32 v95, v95, v88
  v_ashrrev_i32 v88, 31, v106
  v_and_or_b32 v89, v107, 1, v94
  v_bitop3_b32 v88, v106, v88, v92 bitop3:0x1e
  v_sub_u32 v89, 1533, v89
  v_bfi_b32 v88, v87, v89, v88
  v_max_u32 v95, v95, v88
  v_ashrrev_i32 v88, 31, v108
  v_and_or_b32 v89, v109, 1, v94
  v_bitop3_b32 v88, v108, v88, v92 bitop3:0x1e
  v_sub_u32 v89, 1279, v89
  v_bfi_b32 v88, v87, v89, v88
  v_max_u32 v95, v95, v88
  v_ashrrev_i32 v88, 31, v110
  v_and_or_b32 v89, v111, 1, v94
  v_bitop3_b32 v88, v110, v88, v92 bitop3:0x1e
  v_sub_u32 v89, 1277, v89
  v_bfi_b32 v88, v87, v89, v88
  v_max_u32 v95, v95, v88
  v_ashrrev_i32 v88, 31, v112
  v_and_or_b32 v89, v113, 1, v94
  v_bitop3_b32 v88, v112, v88, v92 bitop3:0x1e
  v_sub_u32 v89, 1023, v89
  v_bfi_b32 v88, v87, v89, v88
  v_max_u32 v95, v95, v88
  v_ashrrev_i32 v88, 31, v114
  v_and_or_b32 v89, v115, 1, v94
  v_bitop3_b32 v88, v114, v88, v92 bitop3:0x1e
  v_sub_u32 v89, 1021, v89
  v_bfi_b32 v88, v87, v89, v88
  v_max_u32 v95, v95, v88
  v_ashrrev_i32 v88, 31, v116
  v_and_or_b32 v89, v117, 1, v94
  v_bitop3_b32 v88, v116, v88, v92 bitop3:0x1e
  v_sub_u32 v89, 767, v89
  v_bfi_b32 v88, v87, v89, v88
  v_max_u32 v95, v95, v88
  v_ashrrev_i32 v88, 31, v118
  v_and_or_b32 v89, v119, 1, v94
  v_bitop3_b32 v88, v118, v88, v92 bitop3:0x1e
  v_sub_u32 v89, 765, v89
  v_bfi_b32 v88, v87, v89, v88
  v_max_u32 v95, v95, v88
  v_ashrrev_i32 v88, 31, v120
  v_and_or_b32 v89, v121, 1, v94
  v_bitop3_b32 v88, v120, v88, v92 bitop3:0x1e
  v_sub_u32 v89, 511, v89
  v_bfi_b32 v88, v87, v89, v88
  v_max_u32 v95, v95, v88
  v_ashrrev_i32 v88, 31, v122
  v_and_or_b32 v89, v123, 1, v94
  v_bitop3_b32 v88, v122, v88, v92 bitop3:0x1e
  v_sub_u32 v89, 509, v89
  v_bfi_b32 v88, v87, v89, v88
  v_max_u32 v95, v95, v88
  v_ashrrev_i32 v88, 31, v124
  v_and_or_b32 v89, v125, 1, v94
  v_bitop3_b32 v88, v124, v88, v92 bitop3:0x1e
  v_sub_u32 v89, 255, v89
  v_bfi_b32 v88, v87, v89, v88
  v_max_u32 v95, v95, v88
  v_ashrrev_i32 v88, 31, v126
  v_and_or_b32 v89, v127, 1, v94
  v_bitop3_b32 v88, v126, v88, v92 bitop3:0x1e
  v_sub_u32 v89, 253, v89
  v_bfi_b32 v88, v87, v89, v88
  v_max_u32 v95, v95, v88
  s_nop 1
  v_max_u32_dpp v95, v95, v95 quad_perm:[1,0,3,2] row_mask:0xf bank_mask:0xf
  s_nop 1
  v_max_u32_dpp v95, v95, v95 quad_perm:[2,3,0,1] row_mask:0xf bank_mask:0xf
  s_nop 1
  v_max_u32_dpp v95, v95, v95 row_half_mirror row_mask:0xf bank_mask:0xf
  s_nop 1
  v_max_u32_dpp v95, v95, v95 row_mirror row_mask:0xf bank_mask:0xf
  v_mov_b32 v88, v95
  s_nop 1
  v_permlane16_swap_b32 v95, v88
  v_max_u32 v95, v95, v88
  v_mov_b32 v88, v95
  s_nop 1
  v_permlane32_swap_b32 v95, v88
  v_max_u32 v95, v95, v88
  s_nop 0
  v_readfirstlane_b32 s62, v95
  s_nop 0
  s_and_b32 s62, s62, 0x7ff
  s_sub_u32 s12, 2047, s62
  s_lshl_b32 s62, s12, 4
  s_add_u32 s62, s62, 4096
  v_mov_b32 v32, s62
  buffer_load_dwordx4 v[28:31], v32, s[36:39], 0 offen sc1
  s_mul_i32 s62, s12, 1152
  s_mul_i32 s63, s24, 384
  s_add_u32 s62, s62, s63
  v_min_u32 v33, 23, v1
  v_lshlrev_b32 v33, 4, v33
  s_cmp_lt_u32 s60, 216
  s_cselect_b32 s62, s62, 0x7fff0000
  buffer_load_dwordx4 v[36:39], v33, s[28:31], s62 offen
  s_waitcnt vmcnt(0)
  s_mov_b32 s59, 0
Lpoll_78:
  v_cmp_ne_u32 vcc, s51, v31
  s_nop 0
  s_cbranch_vccz Lpolld_79
  buffer_load_dwordx4 v[28:31], v32, s[36:39], 0 offen sc1
  s_add_u32 s59, s59, 1
  s_cmp_lt_u32 s59, 200000
  s_waitcnt vmcnt(0)
  s_cbranch_scc1 Lpoll_78
Lpolld_79:
  v_mul_f32 v40, 0xbfb8aa3b, v30
  v_exp_f32 v40, v40
  s_nop 0
  v_add_f32 v40, 1.0, v40
  v_rcp_f32 v41, v40
  v_mov_b32 v40, s12
  v_mov_b32 v42, 158560
  ds_write_b64 v42, v[40:41]
  v_mul_f32 v42, v28, v29
  v_lshlrev_b32 v44, 16, v36
  v_and_b32 v45, 0xffff0000, v36
  v_fma_f32 v44, v44, v29, -v42
  v_fma_f32 v45, v45, v29, -v42
  v_cvt_pk_bf16_f32 v36, v44, v45
  v_lshlrev_b32 v44, 16, v37
  v_and_b32 v45, 0xffff0000, v37
  v_fma_f32 v44, v44, v29, -v42
  v_fma_f32 v45, v45, v29, -v42
  v_cvt_pk_bf16_f32 v37, v44, v45
  v_lshlrev_b32 v44, 16, v38
  v_and_b32 v45, 0xffff0000, v38
  v_fma_f32 v44, v44, v29, -v42
  v_fma_f32 v45, v45, v29, -v42
  v_cvt_pk_bf16_f32 v38, v44, v45
  v_lshlrev_b32 v44, 16, v39
  v_and_b32 v45, 0xffff0000, v39
  v_fma_f32 v44, v44, v29, -v42
  v_fma_f32 v45, v45, v29, -v42
  v_cvt_pk_bf16_f32 v39, v44, v45
  v_add_u32 v33, 159488, v33
  ds_write_b128 v33, v[36:39]
  s_waitcnt lgkmcnt(0)
  v_mov_b32 v90, 158248
  v_mov_b32 v91, 1
  s_mov_b64 exec, 1
  ds_add_u32 v90, v91
  s_mov_b64 exec, -1
  v_mov_b32 v90, 158248
  v_mov_b32 v91, 1
  s_mov_b64 exec, 1
  ds_add_u32 v90, v91
  s_mov_b64 exec, -1
  s_branch Lmjoin_75
Lm3_73:
  s_barrier
  s_barrier
  s_barrier
  s_waitcnt lgkmcnt(0)
  s_mul_i32 s61, s61, 0x9e3779b1
  s_add_u32 s51, s61, 0x7f4a7c15
  s_and_b32 s62, s60, 7
  s_lshr_b32 s63, s60, 3
  s_and_b32 s44, s62, 3
  s_lshl_b32 s44, s44, 3
  s_and_b32 s46, s63, 7
  s_add_u32 s44, s44, s46
  s_lshr_b32 s45, s62, 2
  s_lshl_b32 s45, s45, 2
  s_lshr_b32 s46, s63, 3
  s_add_u32 s45, s45, s46
  s_barrier
  s_barrier
  s_barrier
  s_barrier
Lmjoin_75:
  v_mov_b32 v90, 158260
  s_mov_b64 exec, 1
  s_mov_b32 s59, 0
Lls_80:
  ds_read_b32 v91, v90
  s_add_u32 s59, s59, 1
  s_cmp_ge_u32 s59, 4000000
  s_waitcnt lgkmcnt(0)
  v_readfirstlane_b32 s63, v91
  s_cbranch_scc1 Llsd_81
  s_cmp_lt_u32 s63, 2
  s_cbranch_scc1 Lls_80
Llsd_81:
  s_mov_b64 exec, -1
  s_mov_b32 s40, s16
  s_mov_b32 s41, s17
  s_mov_b32 s42, 5308416
  s_mov_b32 s43, 0x00020000
  s_add_u32 s63, s56, 0
  buffer_load_dwordx4 v[128:131], v25, s[40:43], s63 offen nt
  s_add_u32 s63, s56, 73728
  buffer_load_dwordx4 v[132:135], v25, s[40:43], s63 offen nt
  s_add_u32 s63, s56, 147456
  buffer_load_dwordx4 v[136:139], v25, s[40:43], s63 offen nt
  s_add_u32 s63, s56, 221184
  buffer_load_dwordx4 v[140:143], v25, s[40:43], s63 offen nt
  s_add_u32 s63, s56, 294912
  buffer_load_dwordx4 v[144:147], v25, s[40:43], s63 offen nt
  s_add_u32 s63, s56, 368640
  buffer_load_dwordx4 v[148:151], v25, s[40:43], s63 offen nt
  s_add_u32 s63, s56, 442368
  buffer_load_dwordx4 v[152:155], v25, s[40:43], s63 offen nt
  s_add_u32 s63, s56, 516096
  buffer_load_dwordx4 v[156:159], v25, s[40:43], s63 offen nt
  s_add_u32 s63, s56, 589824
  buffer_load_dwordx4 v[160:163], v25, s[40:43], s63 offen nt
  s_add_u32 s63, s56, 663552
  buffer_load_dwordx4 v[164:167], v25, s[40:43], s63 offen nt
  s_add_u32 s63, s56, 737280
  buffer_load_dwordx4 v[168:171], v25, s[40:43], s63 offen nt
  s_add_u32 s63, s56, 811008
  buffer_load_dwordx4 v[172:175], v25, s[40:43], s63 offen nt
  s_mov_b32 s40, s18
  s_mov_b32 s41, s19
  s_mov_b32 s42, 5308416
  s_mov_b32 s43, 0x00020000
  s_add_u32 s63, s56, 0
  buffer_load_dwordx4 v[176:179], v25, s[40:43], s63 offen nt
  s_add_u32 s63, s56, 73728
  buffer_load_dwordx4 v[180:183], v25, s[40:43], s63 offen nt
  s_add_u32 s63, s56, 147456
  buffer_load_dwordx4 v[184:187], v25, s[40:43], s63 offen nt
  s_add_u32 s63, s56, 221184
  buffer_load_dwordx4 v[188:191], v25, s[40:43], s63 offen nt
  s_add_u32 s63, s56, 294912
  buffer_load_dwordx4 v[192:195], v25, s[40:43], s63 offen nt
  s_add_u32 s63, s56, 368640
  buffer_load_dwordx4 v[196:199], v25, s[40:43], s63 offen nt
  s_add_u32 s63, s56, 442368
  buffer_load_dwordx4 v[200:203], v25, s[40:43], s63 offen nt
  s_add_u32 s63, s56, 516096
  buffer_load_dwordx4 v[204:207], v25, s[40:43], s63 offen nt
  s_add_u32 s63, s56, 589824
  buffer_load_dwordx4 v[208:211], v25, s[40:43], s63 offen nt
  s_add_u32 s63, s56, 663552
  buffer_load_dwordx4 v[212:215], v25, s[40:43], s63 offen nt
  s_add_u32 s63, s56, 737280
  buffer_load_dwordx4 v[216:219], v25, s[40:43], s63 offen nt
  s_add_u32 s63, s56, 811008
  buffer_load_dwordx4 v[220:223], v25, s[40:43], s63 offen nt
  s_mov_b32 s40, s20
  s_mov_b32 s41, s21
  s_mov_b32 s42, 5308416
  s_mov_b32 s43, 0x00020000
  v_mov_b32 v62, 0x7fff0000
  v_mul_u32_u24 v60, 1152, v10
  v_lshl_add_u32 v60, v9, 4, v60
  s_cmp_eq_u32 s24, 2
  s_mov_b32 s62, 11
  s_cselect_b32 s62, 2, s62
  v_cmp_gt_u32 vcc, s62, v9
  v_add_u32 v61, 256, v60
  s_nop 0
  v_cndmask_b32 v61, v62, v61, vcc
  s_lshl_b32 s62, s13, 6
  s_lshl_b32 s63, s25, 5
  s_add_u32 s62, s62, s63
  s_mul_i32 s62, s62, 1152
  s_mul_i32 s63, s24, 432
  s_add_u32 s46, s62, s63
  s_cmp_lt_u32 s60, 216
  s_cselect_b32 s46, s46, 0x7fff0000
  s_add_u32 s63, s46, 0
  buffer_load_dwordx4 v[96:99], v60, s[40:43], s63 offen nt
  buffer_load_dwordx4 v[100:103], v61, s[40:43], s63 offen nt
  s_add_u32 s63, s46, 4608
  buffer_load_dwordx4 v[104:107], v60, s[40:43], s63 offen nt
  buffer_load_dwordx4 v[108:111], v61, s[40:43], s63 offen nt
  s_add_u32 s63, s46, 9216
  buffer_load_dwordx4 v[112:115], v60, s[40:43], s63 offen nt
  buffer_load_dwordx4 v[116:119], v61, s[40:43], s63 offen nt
  s_add_u32 s63, s46, 13824
  buffer_load_dwordx4 v[120:123], v60, s[40:43], s63 offen nt
  buffer_load_dwordx4 v[124:127], v61, s[40:43], s63 offen nt
  s_add_u32 s63, s46, 18432
  buffer_load_dwordx4 v[224:227], v60, s[40:43], s63 offen nt
  buffer_load_dwordx4 v[228:231], v61, s[40:43], s63 offen nt
  s_add_u32 s63, s46, 23040
  buffer_load_dwordx4 v[232:235], v60, s[40:43], s63 offen nt
  buffer_load_dwordx4 v[236:239], v61, s[40:43], s63 offen nt
  s_add_u32 s63, s46, 27648
  buffer_load_dwordx4 v[240:243], v60, s[40:43], s63 offen nt
  buffer_load_dwordx4 v[244:247], v61, s[40:43], s63 offen nt
  s_add_u32 s63, s46, 32256
  buffer_load_dwordx4 v[248:251], v60, s[40:43], s63 offen nt
  buffer_load_dwordx4 v[252:255], v61, s[40:43], s63 offen nt
  s_cmp_lt_u32 s60, 216
  s_cbranch_scc0 Lmoe1_82
  v_mov_b32 v90, 158248
  s_mov_b64 exec, 1
  s_mov_b32 s59, 0
Lls_83:
  ds_read_b32 v91, v90
  s_add_u32 s59, s59, 1
  s_cmp_ge_u32 s59, 4000000
  s_waitcnt lgkmcnt(0)
  v_readfirstlane_b32 s63, v91
  s_cbranch_scc1 Llsd_84
  s_cmp_lt_u32 s63, 2
  s_cbranch_scc1 Lls_83
Llsd_84:
  s_mov_b64 exec, -1
  s_mul_i32 s62, s25, 192
  s_add_u32 s62, s62, 159488
  v_lshl_add_u32 v33, v24, 1, s62
  ds_read_u16 v40, v33 offset:0
  ds_read_u16 v41, v33 offset:16
  ds_read_u16 v42, v33 offset:32
  ds_read_u16 v43, v33 offset:48
  ds_read_u16 v44, v33 offset:64
  ds_read_u16 v45, v33 offset:80
  ds_read_u16 v46, v33 offset:96
  ds_read_u16 v47, v33 offset:112
  ds_read_u16 v48, v33 offset:128
  ds_read_u16 v49, v33 offset:144
  ds_read_u16 v50, v33 offset:160
  ds_read_u16 v51, v33 offset:176
  s_waitcnt lgkmcnt(0)
  v_lshl_or_b32 v40, v40, 16, v40
  v_lshl_or_b32 v41, v41, 16, v41
  v_lshl_or_b32 v42, v42, 16, v42
  v_lshl_or_b32 v43, v43, 16, v43
  v_lshl_or_b32 v44, v44, 16, v44
  v_lshl_or_b32 v45, v45, 16, v45
  v_lshl_or_b32 v46, v46, 16, v46
  v_lshl_or_b32 v47, v47, 16, v47
  v_lshl_or_b32 v48, v48, 16, v48
  v_lshl_or_b32 v49, v49, 16, v49
  v_lshl_or_b32 v50, v50, 16, v50
  v_lshl_or_b32 v51, v51, 16, v51
  s_waitcnt vmcnt(16)
  v_and_b32 v72, v40, v16
  v_and_b32 v73, v40, v17
  v_and_b32 v74, v40, v18
  v_and_b32 v75, v40, v19
  s_nop 1
  v_mfma_f32_16x16x32_bf16 v[64:67], v[128:131], v[72:75], 0
  v_mfma_f32_16x16x32_bf16 v[68:71], v[176:179], v[72:75], 0
  v_and_b32 v76, v41, v16
  v_and_b32 v77, v41, v17
  v_and_b32 v78, v41, v18
  v_and_b32 v79, v41, v19
  s_nop 1
  v_mfma_f32_16x16x32_bf16 v[64:67], v[132:135], v[76:79], v[64:67]
  v_mfma_f32_16x16x32_bf16 v[68:71], v[180:183], v[76:79], v[68:71]
  v_and_b32 v72, v42, v16
  v_and_b32 v73, v42, v17
  v_and_b32 v74, v42, v18
  v_and_b32 v75, v42, v19
  s_nop 1
  v_mfma_f32_16x16x32_bf16 v[64:67], v[136:139], v[72:75], v[64:67]
  v_mfma_f32_16x16x32_bf16 v[68:71], v[184:187], v[72:75], v[68:71]
  v_and_b32 v76, v43, v16
  v_and_b32 v77, v43, v17
  v_and_b32 v78, v43, v18
  v_and_b32 v79, v43, v19
  s_nop 1
  v_mfma_f32_16x16x32_bf16 v[64:67], v[140:143], v[76:79], v[64:67]
  v_mfma_f32_16x16x32_bf16 v[68:71], v[188:191], v[76:79], v[68:71]
  v_and_b32 v72, v44, v16
  v_and_b32 v73, v44, v17
  v_and_b32 v74, v44, v18
  v_and_b32 v75, v44, v19
  s_nop 1
  v_mfma_f32_16x16x32_bf16 v[64:67], v[144:147], v[72:75], v[64:67]
  v_mfma_f32_16x16x32_bf16 v[68:71], v[192:195], v[72:75], v[68:71]
  v_and_b32 v76, v45, v16
  v_and_b32 v77, v45, v17
  v_and_b32 v78, v45, v18
  v_and_b32 v79, v45, v19
  s_nop 1
  v_mfma_f32_16x16x32_bf16 v[64:67], v[148:151], v[76:79], v[64:67]
  v_mfma_f32_16x16x32_bf16 v[68:71], v[196:199], v[76:79], v[68:71]
  v_and_b32 v72, v46, v16
  v_and_b32 v73, v46, v17
  v_and_b32 v74, v46, v18
  v_and_b32 v75, v46, v19
  s_nop 1
  v_mfma_f32_16x16x32_bf16 v[64:67], v[152:155], v[72:75], v[64:67]
  v_mfma_f32_16x16x32_bf16 v[68:71], v[200:203], v[72:75], v[68:71]
  v_and_b32 v76, v47, v16
  v_and_b32 v77, v47, v17
  v_and_b32 v78, v47, v18
  v_and_b32 v79, v47, v19
  s_nop 1
  v_mfma_f32_16x16x32_bf16 v[64:67], v[156:159], v[76:79], v[64:67]
  v_mfma_f32_16x16x32_bf16 v[68:71], v[204:207], v[76:79], v[68:71]
  v_and_b32 v72, v48, v16
  v_and_b32 v73, v48, v17
  v_and_b32 v74, v48, v18
  v_and_b32 v75, v48, v19
  s_nop 1
  v_mfma_f32_16x16x32_bf16 v[64:67], v[160:163], v[72:75], v[64:67]
  v_mfma_f32_16x16x32_bf16 v[68:71], v[208:211], v[72:75], v[68:71]
  v_and_b32 v76, v49, v16
  v_and_b32 v77, v49, v17
  v_and_b32 v78, v49, v18
  v_and_b32 v79, v49, v19
  s_nop 1
  v_mfma_f32_16x16x32_bf16 v[64:67], v[164:167], v[76:79], v[64:67]
  v_mfma_f32_16x16x32_bf16 v[68:71], v[212:215], v[76:79], v[68:71]
  v_and_b32 v72, v50, v16
  v_and_b32 v73, v50, v17
  v_and_b32 v74, v50, v18
  v_and_b32 v75, v50, v19
  s_nop 1
  v_mfma_f32_16x16x32_bf16 v[64:67], v[168:171], v[72:75], v[64:67]
  v_mfma_f32_16x16x32_bf16 v[68:71], v[216:219], v[72:75], v[68:71]
  v_and_b32 v76, v51, v16
  v_and_b32 v77, v51, v17
  v_and_b32 v78, v51, v18
  v_and_b32 v79, v51, v19
  s_nop 1
  v_mfma_f32_16x16x32_bf16 v[64:67], v[172:175], v[76:79], v[64:67]
  v_mfma_f32_16x16x32_bf16 v[68:71], v[220:223], v[76:79], v[68:71]
  s_nop 6
  v_mov_b32 v40, v64
  v_mov_b32 v48, v64
  v_mov_b32 v41, v65
  v_mov_b32 v49, v65
  v_mov_b32 v42, v66
  v_mov_b32 v50, v66
  v_mov_b32 v43, v67
  v_mov_b32 v51, v67
  v_mov_b32 v44, v68
  v_mov_b32 v52, v68
  v_mov_b32 v45, v69
  v_mov_b32 v53, v69
  v_mov_b32 v46, v70
  v_mov_b32 v54, v70
  v_mov_b32 v47, v71
  v_mov_b32 v55, v71
  v_permlane32_swap_b32 v40, v48
  v_permlane32_swap_b32 v41, v49
  v_permlane32_swap_b32 v42, v50
  v_permlane32_swap_b32 v43, v51
  v_permlane32_swap_b32 v44, v52
  v_permlane32_swap_b32 v45, v53
  v_permlane32_swap_b32 v46, v54
  v_permlane32_swap_b32 v47, v55
  v_add_f32_dpp v64, v48, v64 row_ror:8 row_mask:0xf bank_mask:0xf
  v_add_f32_dpp v65, v49, v65 row_ror:8 row_mask:0xf bank_mask:0xf
  v_add_f32_dpp v66, v50, v66 row_ror:8 row_mask:0xf bank_mask:0xf
  v_add_f32_dpp v67, v51, v67 row_ror:8 row_mask:0xf bank_mask:0xf
  v_add_f32_dpp v68, v52, v68 row_ror:8 row_mask:0xf bank_mask:0xf
  v_add_f32_dpp v69, v53, v69 row_ror:8 row_mask:0xf bank_mask:0xf
  v_add_f32_dpp v70, v54, v70 row_ror:8 row_mask:0xf bank_mask:0xf
  v_add_f32_dpp v71, v55, v71 row_ror:8 row_mask:0xf bank_mask:0xf
  v_lshl_add_u32 v33, v10, 5, v9
  v_lshlrev_b32 v33, 4, v33
  v_cmp_gt_u32 vcc, 8, v9
  v_cmp_gt_u32 s[62:63], 2, v10
  s_nop 0
  s_and_b64 vcc, vcc, s[62:63]
  v_mov_b32 v34, 0x7fff0000
  v_cndmask_b32 v33, v34, v33, vcc
  s_mul_i32 s62, s13, 6144
  s_lshl_b32 s63, s24, 11
  s_add_u32 s62, s62, s63
  s_lshl_b32 s63, s25, 10
  s_add_u32 s62, s62, s63
  s_add_u32 s46, s62, 6291456
  v_mov_b32 v40, v64
  v_mov_b32 v41, v68
  v_mov_b32 v42, s51
  v_mov_b32 v43, 0
  buffer_store_dwordx4 v[40:43], v33, s[36:39], s46 offen offset:0 sc1
  v_mov_b32 v44, v65
  v_mov_b32 v45, v69
  v_mov_b32 v46, s51
  v_mov_b32 v47, 0
  buffer_store_dwordx4 v[44:47], v33, s[36:39], s46 offen offset:128 sc1
  v_mov_b32 v48, v66
  v_mov_b32 v49, v70
  v_mov_b32 v50, s51
  v_mov_b32 v51, 0
  buffer_store_dwordx4 v[48:51], v33, s[36:39], s46 offen offset:256 sc1
  v_mov_b32 v52, v67
  v_mov_b32 v53, v71
  v_mov_b32 v54, s51
  v_mov_b32 v55, 0
  buffer_store_dwordx4 v[52:55], v33, s[36:39], s46 offen offset:384 sc1
  v_lshlrev_b32 v32, 4, v1
  s_mul_i32 s46, s13, 6144
  s_add_u32 s46, s46, 6291456
  v_min_u32 v36, 5, v1
  v_lshlrev_b32 v36, 10, v36
  v_add_u32 v36, 1016, v36
  s_mov_b32 s59, 0
Lgw_85:
  buffer_load_dword v37, v36, s[36:39], s46 offen sc1
  s_add_u32 s59, s59, 1
  s_waitcnt vmcnt(0)
  v_cmp_ne_u32 vcc, s51, v37
  s_nop 0
  s_cbranch_vccz Lgwd_86
  s_sleep 8
  s_cmp_lt_u32 s59, 200000
  s_cbranch_scc1 Lgw_85
Lgwd_86:
  s_mov_b32 s59, 0
Lgp_87:
  s_add_u32 s63, s46, 0
  buffer_load_dwordx4 v[40:43], v32, s[36:39], s63 offen sc1
  s_add_u32 s63, s46, 1024
  buffer_load_dwordx4 v[44:47], v32, s[36:39], s63 offen sc1
  s_add_u32 s63, s46, 2048
  buffer_load_dwordx4 v[48:51], v32, s[36:39], s63 offen sc1
  s_add_u32 s63, s46, 3072
  buffer_load_dwordx4 v[52:55], v32, s[36:39], s63 offen sc1
  s_add_u32 s63, s46, 4096
  buffer_load_dwordx4 v[56:59], v32, s[36:39], s63 offen sc1
  s_add_u32 s63, s46, 5120
  buffer_load_dwordx4 v[60:63], v32, s[36:39], s63 offen sc1
  s_add_u32 s59, s59, 1
  s_waitcnt vmcnt(0)
  v_cmp_ne_u32 vcc, s51, v42
  v_cmp_ne_u32 s[62:63], s51, v46
  s_nop 0
  s_or_b64 vcc, vcc, s[62:63]
  v_cmp_ne_u32 s[62:63], s51, v50
  s_nop 0
  s_or_b64 vcc, vcc, s[62:63]
  v_cmp_ne_u32 s[62:63], s51, v54
  s_nop 0
  s_or_b64 vcc, vcc, s[62:63]
  v_cmp_ne_u32 s[62:63], s51, v58
  s_nop 0
  s_or_b64 vcc, vcc, s[62:63]
  v_cmp_ne_u32 s[62:63], s51, v62
  s_nop 0
  s_or_b64 vcc, vcc, s[62:63]
  s_cbranch_vccz Lgd_88
  s_sleep 8
  s_cmp_lt_u32 s59, 200000
  s_cbranch_scc1 Lgp_87
Lgd_88:
  v_add_f32 v40, v40, v44
  v_add_f32 v41, v41, v45
  v_add_f32 v40, v40, v48
  v_add_f32 v41, v41, v49
  v_add_f32 v40, v40, v52
  v_add_f32 v41, v41, v53
  v_add_f32 v40, v40, v56
  v_add_f32 v41, v41, v57
  v_add_f32 v40, v40, v60
  v_add_f32 v41, v41, v61
  v_mul_f32 v42, 0xbfb8aa3b, v40
  v_exp_f32 v42, v42
  s_nop 0
  v_add_f32 v42, 1.0, v42
  v_rcp_f32 v42, v42
  s_nop 0
  v_mul_f32 v40, v40, v42
  v_mul_f32 v40, v40, v41
  v_cvt_pk_bf16_f32 v40, v40, v40
  s_lshl_b32 s62, s25, 7
  s_add_u32 s62, s62, 160256
  v_lshlrev_b32 v41, 1, v1
  v_add_u32 v41, s62, v41
  ds_write_b16 v41, v40
  s_lshl_b32 s63, s25, 6
  s_add_u32 s62, s62, s63
  v_lshl_add_u32 v33, v10, 1, s62
  s_waitcnt lgkmcnt(0)
  ds_read_u16 v48, v33 offset:0
  ds_read_u16 v49, v33 offset:8
  ds_read_u16 v50, v33 offset:16
  ds_read_u16 v51, v33 offset:24
  ds_read_u16 v52, v33 offset:32
  ds_read_u16 v53, v33 offset:40
  ds_read_u16 v54, v33 offset:48
  ds_read_u16 v55, v33 offset:56
  s_waitcnt lgkmcnt(0)
  v_lshl_or_b32 v48, v48, 16, v48
  v_lshl_or_b32 v49, v49, 16, v49
  v_lshl_or_b32 v50, v50, 16, v50
  v_lshl_or_b32 v51, v51, 16, v51
  v_lshl_or_b32 v52, v52, 16, v52
  v_lshl_or_b32 v53, v53, 16, v53
  v_lshl_or_b32 v54, v54, 16, v54
  v_lshl_or_b32 v55, v55, 16, v55
  v_and_b32 v72, v48, v20
  v_and_b32 v73, v48, v21
  v_and_b32 v74, v48, v22
  v_and_b32 v75, v48, v23
  s_nop 1
  v_mfma_f32_16x16x32_bf16 v[64:67], v[96:99], v[72:75], 0
  v_mfma_f32_16x16x32_bf16 v[68:71], v[100:103], v[72:75], 0
  v_and_b32 v76, v49, v20
  v_and_b32 v77, v49, v21
  v_and_b32 v78, v49, v22
  v_and_b32 v79, v49, v23
  s_nop 1
  v_mfma_f32_16x16x32_bf16 v[64:67], v[104:107], v[76:79], v[64:67]
  v_mfma_f32_16x16x32_bf16 v[68:71], v[108:111], v[76:79], v[68:71]
  v_and_b32 v72, v50, v20
  v_and_b32 v73, v50, v21
  v_and_b32 v74, v50, v22
  v_and_b32 v75, v50, v23
  s_nop 1
  v_mfma_f32_16x16x32_bf16 v[64:67], v[112:115], v[72:75], v[64:67]
  v_mfma_f32_16x16x32_bf16 v[68:71], v[116:119], v[72:75], v[68:71]
  v_and_b32 v76, v51, v20
  v_and_b32 v77, v51, v21
  v_and_b32 v78, v51, v22
  v_and_b32 v79, v51, v23
  s_nop 1
  v_mfma_f32_16x16x32_bf16 v[64:67], v[120:123], v[76:79], v[64:67]
  v_mfma_f32_16x16x32_bf16 v[68:71], v[124:127], v[76:79], v[68:71]
  v_and_b32 v72, v52, v20
  v_and_b32 v73, v52, v21
  v_and_b32 v74, v52, v22
  v_and_b32 v75, v52, v23
  s_nop 1
  v_mfma_f32_16x16x32_bf16 v[64:67], v[224:227], v[72:75], v[64:67]
  v_mfma_f32_16x16x32_bf16 v[68:71], v[228:231], v[72:75], v[68:71]
  v_and_b32 v76, v53, v20
  v_and_b32 v77, v53, v21
  v_and_b32 v78, v53, v22
  v_and_b32 v79, v53, v23
  s_nop 1
  v_mfma_f32_16x16x32_bf16 v[64:67], v[232:235], v[76:79], v[64:67]
  v_mfma_f32_16x16x32_bf16 v[68:71], v[236:239], v[76:79], v[68:71]
  v_and_b32 v72, v54, v20
  v_and_b32 v73, v54, v21
  v_and_b32 v74, v54, v22
  v_and_b32 v75, v54, v23
  s_nop 1
  v_mfma_f32_16x16x32_bf16 v[64:67], v[240:243], v[72:75], v[64:67]
  v_mfma_f32_16x16x32_bf16 v[68:71], v[244:247], v[72:75], v[68:71]
  v_and_b32 v76, v55, v20
  v_and_b32 v77, v55, v21
  v_and_b32 v78, v55, v22
  v_and_b32 v79, v55, v23
  s_nop 1
  v_mfma_f32_16x16x32_bf16 v[64:67], v[248:251], v[76:79], v[64:67]
  v_mfma_f32_16x16x32_bf16 v[68:71], v[252:255], v[76:79], v[68:71]
  v_lshlrev_b32 v33, 7, v10
  v_lshl_add_u32 v33, v9, 2, v33
  v_add_u32 v33, 158592, v33
  v_cmp_gt_u32 vcc, 8, v9
  s_nop 0
  s_and_saveexec_b64 s[62:63], vcc
  s_nop 0
  ds_add_f32 v33, v64 offset:0
  ds_add_f32 v33, v65 offset:32
  ds_add_f32 v33, v66 offset:64
  ds_add_f32 v33, v67 offset:96
  ds_add_f32 v33, v68 offset:512
  ds_add_f32 v33, v69 offset:544
  ds_add_f32 v33, v70 offset:576
  ds_add_f32 v33, v71 offset:608
  s_mov_b64 exec, s[62:63]
  s_waitcnt lgkmcnt(0)
  v_mov_b32 v90, 158244
  s_mov_b64 exec, 1
  s_mov_b32 s59, 0
  v_mov_b32 v91, 1
  ds_add_rtn_u32 v91, v90, v91
  s_waitcnt lgkmcnt(0)
  v_readfirstlane_b32 s63, v91
  s_nop 0
  s_cmp_ge_u32 s63, 1
  s_cbranch_scc1 Llsd_90
Lls_89:
  ds_read_b32 v91, v90
  s_add_u32 s59, s59, 1
  s_cmp_ge_u32 s59, 4000000
  s_waitcnt lgkmcnt(0)
  v_readfirstlane_b32 s63, v91
  s_cbranch_scc1 Llsd_90
  s_cmp_lt_u32 s63, 2
  s_cbranch_scc1 Lls_89
Llsd_90:
  s_mov_b64 exec, -1
  v_mul_u32_u24 v33, 24, v1
  v_min_u32 v33, 840, v33
  v_add_u32 v33, 158592, v33
  ds_read_b64 v[40:41], v33
  ds_read_b64 v[42:43], v33 offset:8
  ds_read_b64 v[44:45], v33 offset:16
  s_cmp_eq_u32 s24, 2
  s_mov_b32 s62, 36
  s_cselect_b32 s62, 24, s62
  s_cmp_eq_u32 s25, 0
  s_cselect_b32 s62, s62, 0
  v_cmp_gt_u32 vcc, s62, v1
  v_lshlrev_b32 v33, 4, v1
  s_nop 0
  v_cndmask_b32 v33, v34, v33, vcc
  s_mul_i32 s62, s13, 1536
  s_mul_i32 s63, s24, 576
  s_add_u32 s62, s62, s63
  s_add_u32 s46, s62, 6733824
  s_and_b32 s62, s51, 0xbfffbfff
  v_mov_b32 v51, s62
  s_waitcnt lgkmcnt(0)
  v_cvt_pk_bf16_f32 v48, v40, v41
  v_cvt_pk_bf16_f32 v49, v42, v43
  v_cvt_pk_bf16_f32 v50, v44, v45
  buffer_store_dwordx4 v[48:51], v33, s[36:39], s46 offen sc1
Lmoe1_82:
  v_mov_b32 v90, 158248
  s_mov_b64 exec, 1
  s_mov_b32 s59, 0
Lls_92:
  ds_read_b32 v91, v90
  s_add_u32 s59, s59, 1
  s_cmp_ge_u32 s59, 4000000
  s_waitcnt lgkmcnt(0)
  v_readfirstlane_b32 s63, v91
  s_cbranch_scc1 Llsd_93
  s_cmp_lt_u32 s63, 2
  s_cbranch_scc1 Lls_92
Llsd_93:
  s_mov_b64 exec, -1
  v_mov_b32 v40, 158560
  ds_read_b32 v41, v40
  s_waitcnt lgkmcnt(0)
  v_readfirstlane_b32 s12, v41
  s_nop 0
  s_lshr_b32 s62, s12, 6
  s_cmp_eq_u32 s62, s44
  s_cbranch_scc0 Lnoown_91
  v_mul_u32_u24 v94, 1536, v10
  v_lshl_add_u32 v94, v9, 4, v94
  v_mov_b32 v95, 0x7fff0000
  v_cmp_gt_u32 s[2:3], 12, v9
  s_nop 1
  v_cndmask_b32 v94, v95, v94, s[2:3]
  s_mul_i32 s62, s45, 192
  s_mul_i32 s63, s25, 6144
  s_add_u32 s62, s62, s63
  s_add_u32 s46, s62, 6733824
  s_and_b32 s25, s51, 0xbfffbfff
  s_mov_b32 s59, 0
Lyp_94:
  s_add_u32 s63, s46, 0
  buffer_load_dwordx4 v[96:99], v94, s[36:39], s63 offen sc1
  s_add_u32 s63, s46, 12288
  buffer_load_dwordx4 v[100:103], v94, s[36:39], s63 offen sc1
  s_add_u32 s63, s46, 24576
  buffer_load_dwordx4 v[104:107], v94, s[36:39], s63 offen sc1
  s_add_u32 s63, s46, 36864
  buffer_load_dwordx4 v[108:111], v94, s[36:39], s63 offen sc1
  s_add_u32 s63, s46, 49152
  buffer_load_dwordx4 v[112:115], v94, s[36:39], s63 offen sc1
  s_add_u32 s63, s46, 61440
  buffer_load_dwordx4 v[116:119], v94, s[36:39], s63 offen sc1
  s_add_u32 s63, s46, 73728
  buffer_load_dwordx4 v[120:123], v94, s[36:39], s63 offen sc1
  s_add_u32 s63, s46, 86016
  buffer_load_dwordx4 v[124:127], v94, s[36:39], s63 offen sc1
  s_add_u32 s63, s46, 98304
  buffer_load_dwordx4 v[128:131], v94, s[36:39], s63 offen sc1
  s_add_u32 s59, s59, 1
  s_waitcnt vmcnt(0)
  v_cmp_ne_u32 vcc, s25, v99
  v_cmp_ne_u32 s[62:63], s25, v103
  s_nop 0
  s_or_b64 vcc, vcc, s[62:63]
  v_cmp_ne_u32 s[62:63], s25, v107
  s_nop 0
  s_or_b64 vcc, vcc, s[62:63]
  v_cmp_ne_u32 s[62:63], s25, v111
  s_nop 0
  s_or_b64 vcc, vcc, s[62:63]
  v_cmp_ne_u32 s[62:63], s25, v115
  s_nop 0
  s_or_b64 vcc, vcc, s[62:63]
  v_cmp_ne_u32 s[62:63], s25, v119
  s_nop 0
  s_or_b64 vcc, vcc, s[62:63]
  v_cmp_ne_u32 s[62:63], s25, v123
  s_nop 0
  s_or_b64 vcc, vcc, s[62:63]
  v_cmp_ne_u32 s[62:63], s25, v127
  s_nop 0
  s_or_b64 vcc, vcc, s[62:63]
  v_cmp_ne_u32 s[62:63], s25, v131
  s_nop 0
  s_or_b64 vcc, vcc, s[62:63]
  s_and_b64 vcc, vcc, s[2:3]
  s_cbranch_vccz Lyd_95
  s_cmp_lt_u32 s59, 200000
  s_cbranch_scc1 Lyp_94
Lyd_95:
  v_mfma_f32_16x16x32_bf16 v[64:67], v[12:15], v[96:99], 0
  v_mfma_f32_16x16x32_bf16 v[64:67], v[12:15], v[100:103], v[64:67]
  v_mfma_f32_16x16x32_bf16 v[64:67], v[12:15], v[104:107], v[64:67]
  v_mfma_f32_16x16x32_bf16 v[64:67], v[12:15], v[108:111], v[64:67]
  v_mfma_f32_16x16x32_bf16 v[64:67], v[12:15], v[112:115], v[64:67]
  v_mfma_f32_16x16x32_bf16 v[64:67], v[12:15], v[116:119], v[64:67]
  v_mfma_f32_16x16x32_bf16 v[64:67], v[12:15], v[120:123], v[64:67]
  v_mfma_f32_16x16x32_bf16 v[64:67], v[12:15], v[124:127], v[64:67]
  v_mfma_f32_16x16x32_bf16 v[64:67], v[12:15], v[128:131], v[64:67]
  v_mul_u32_u24 v94, 24, v9
  v_lshl_add_u32 v94, v10, 4, v94
  v_add_u32 v94, 158272, v94
  v_cmp_gt_u32 vcc, 2, v10
  s_nop 0
  s_and_b64 vcc, vcc, s[2:3]
  s_and_saveexec_b64 s[62:63], vcc
  s_nop 0
  ds_add_f32 v94, v64 offset:0
  ds_add_f32 v94, v65 offset:4
  s_mov_b32 exec_hi, 0
  s_and_b32 exec_lo, exec_lo, 0xffff
  ds_add_f32 v94, v66 offset:8
  ds_add_f32 v94, v67 offset:12
  s_mov_b64 exec, s[62:63]
  s_waitcnt lgkmcnt(0)
  v_mov_b32 v90, 158240
  v_mov_b32 v91, 1
  s_mov_b64 exec, 1
  ds_add_u32 v90, v91
  s_mov_b64 exec, -1
Lnoown_91:
  s_waitcnt vmcnt(0) lgkmcnt(0)
L_end:
  s_endpgm
.section .rodata,"a"
.p2align 6
.amdhsa_kernel parallel_sum__linear_kernel_hedgehog__moe_arch_mod__prompt_kernel
  .amdhsa_next_free_vgpr 256
  .amdhsa_next_free_sgpr 102
  .amdhsa_accum_offset 256
  .amdhsa_group_segment_fixed_size 0
  .amdhsa_kernarg_size 96
  .amdhsa_user_sgpr_count 2
  .amdhsa_user_sgpr_kernarg_segment_ptr 1
  .amdhsa_system_sgpr_workgroup_id_x 1
.end_amdhsa_kernel
```
